```python
import torch

def _softmax(x, axis=-1):
    return torch.softmax(x, dim=axis)
def _gelu(x):
    return torch.nn.functional.gelu(x, approximate="tanh")
def _silu(x):
    return torch.nn.functional.silu(x)
def _sigmoid(x):
    return torch.sigmoid(x)
def _layernorm(x, axis=-1, eps=1e-5):
    m = x.mean(dim=axis, keepdim=True)
    v = x.var(dim=axis, keepdim=True, unbiased=False)
    return (x - m) / torch.sqrt(v + eps)
def _scatter_add(tgt, idx, src, axis=0):
    return tgt.clone().index_add_(axis, idx, src)
def _segment_sum(src, seg, n):
    out = torch.zeros((n,) + src.shape[1:], dtype=src.dtype)
    return out.index_add_(0, seg, src)
def _pad(x, pw):
    flat = tuple(v for pair in reversed(pw) for v in pair)
    return torch.nn.functional.pad(x, flat)

kernel_name = 'standalone__deep_cross_wide_deep__recsys'

def setup_inputs():

    _w = (lambda a: (lambda t: t.to(torch.bfloat16) if t.is_floating_point() else t)(torch.as_tensor(a)))
    B, F, D = 16384, 100, 32
    V, Nd = min(100000, 100000), 13
    Din = F * D
    H = 4 * D
    return {
        "idx": _w((lambda lo, hi, *s: torch.randint(lo, hi, s))(0, V, B, F).to(torch.int64)),
        "table": _w((lambda *s: torch.randn(*s, dtype=torch.bfloat16) * 1.6)(V, D) * 0.05),
        "x_wide": _w((lambda *s: torch.randn(*s, dtype=torch.bfloat16) * 0.8)(B, Nd)),
        "w_wide": _w((lambda *s: torch.randn(*s, dtype=torch.bfloat16) * 0.8)(Nd) * 0.05),
        "b_wide": _w((lambda *s: torch.randn(*s, dtype=torch.bfloat16) * 0.8)(1) * 0.01),
        "W1": _w((lambda *s: torch.randn(*s, dtype=torch.bfloat16) * 1.6)(Din, H) * (2.0 / Din) ** 0.5),
        "b1": _w((lambda *s: torch.randn(*s, dtype=torch.bfloat16) * 1.6)(H) * 0.01),
        "W2": _w((lambda *s: torch.randn(*s, dtype=torch.bfloat16) * 1.6)(H) * (1.0 / H) ** 0.5),
        "b2": _w((lambda *s: torch.randn(*s, dtype=torch.bfloat16) * 1.6)(1) * 0.01),
    }

def reference(idx, table, x_wide, w_wide, b_wide, W1, b1, W2, b2):
    emb = table[idx]
    deep_in = emb.reshape(emb.shape[0], -1)
    h = deep_in @ W1 + b1
    h = h * (lambda x, dt: x.to(dt))(h > 0, h.dtype)
    deep_logit = h @ W2 + b2
    wide_logit = x_wide @ w_wide + b_wide
    return _sigmoid(wide_logit + deep_logit)
```

```asm
; @launch grid=(256,1,1) block=(256,1,1) lds=163840
.amdgcn_target "amdgcn-amd-amdhsa--gfx950"
.text
.globl standalone__deep_cross_wide_deep__recsys_kernel
.p2align 8
.type standalone__deep_cross_wide_deep__recsys_kernel,@function
standalone__deep_cross_wide_deep__recsys_kernel:
    s_cmp_ge_u32 s2, 256
    s_cbranch_scc1 L_done
    s_load_dwordx16 s[44:59], s[0:1], 0
    s_load_dwordx8 s[60:67], s[0:1], 64
    v_lshrrev_b32 v6, 6, v0
    v_and_b32 v1, 63, v0
    v_readfirstlane_b32 s3, v6
    v_and_b32 v2, 3, v1
    v_lshrrev_b32 v7, 2, v1
    v_mul_u32_u24 v20, 400, v7
    v_lshl_add_u32 v3, v2, 4, v20
    v_lshlrev_b32 v6, 7, v1
    v_cmp_gt_u32 vcc, 25, v1
    s_and_b32 s77, s2, 1
    s_and_b32 s91, s2, 0xfffffffe
    s_lshl_b32 s91, s91, 6
    s_lshl_b32 s7, s3, 4
    s_add_u32 s91, s91, s7
    s_lshl_b32 s7, s77, 6
    s_add_u32 s5, s91, s7
    s_sub_u32 s4, s91, s7
    s_add_u32 s4, s4, 64
    s_mul_i32 s4, s4, 400
    s_mul_i32 s7, s77, 200
    s_add_u32 s4, s4, s7
    s_mul_i32 s6, s77, 409600
    s_lshr_b32 s77, s2, 3
    s_and_b32 s77, s77, 31
    s_mul_i32 s77, s77, 12800
    s_mul_i32 s91, s3, 3200
    s_add_u32 s77, s77, s91
    s_add_u32 s77, s77, s6
    s_mov_b32 s18, 819200
    s_mov_b32 s19, 0x20000
    s_mov_b32 s10, 6553600
    s_mov_b32 s11, 0x20000
    s_waitcnt lgkmcnt(0)
    s_mov_b32 s16, s54
    s_and_b32 s17, s55, 0xffff
    s_mov_b32 s8, s44
    s_and_b32 s9, s45, 0xffff
    s_mov_b64 exec, vcc
    buffer_load_dword v20, v6, s[16:19], s77 offen
    s_mov_b64 exec, -1
    buffer_load_dwordx4 v[72:75], v3, s[8:11], s4 offen offset:0 nt
    buffer_load_dwordx4 v[76:79], v3, s[8:11], s4 offen offset:64 nt
    buffer_load_dwordx4 v[80:83], v3, s[8:11], s4 offen offset:128 nt
    buffer_load_dwordx2 v[84:85], v3, s[8:11], s4 offen offset:192 nt
    s_mul_i32 s5, s5, 400
    s_add_u32 s5, s5, s7
    s_mul_i32 s92, s3, 10240
    s_lshl_b32 s7, s3, 10
    s_cmp_eq_u32 s3, 0
    s_cselect_b64 s[100:101], -1, 0
    v_lshrrev_b32 v7, 4, v1
    v_lshlrev_b32 v4, 2, v7
    v_and_b32 v6, 15, v1
    v_xor_b32 v4, v4, v6
    v_lshlrev_b32 v4, 4, v4
    v_lshl_add_u32 v4, v7, 8, v4
    s_mov_b32 s32, s48
    s_and_b32 s33, s49, 0xffff
    s_mov_b32 s34, 425984
    s_mov_b32 s35, 0x20000
    s_lshr_b32 s77, s2, 1
    s_lshl_b32 s77, s77, 7
    s_and_b32 s91, s2, 1
    s_lshl_b32 s91, s91, 6
    s_add_u32 s77, s77, s91
    s_mul_i32 s77, s77, 26
    v_mul_u32_u24 v21, 26, v1
    s_mov_b64 exec, s[100:101]
    buffer_load_dwordx4 v[64:67], v21, s[32:35], s77 offen
    buffer_load_dwordx2 v[68:69], v21, s[32:35], s77 offen offset:16
    buffer_load_ushort v70, v21, s[32:35], s77 offen offset:24
    s_mov_b64 exec, -1
    s_add_u32 s6, s6, s92
    s_mov_b32 s12, s46
    s_and_b32 s13, s47, 0xffff
    s_mov_b32 s14, 6400000
    s_mov_b32 s15, 0x20000
    s_mov_b32 s20, s66
    s_and_b32 s21, s67, 0xffff
    s_mov_b32 s22, 9437184
    s_mov_b32 s23, 0x20000
    s_mov_b32 s24, s64
    s_and_b32 s25, s65, 0xffff
    s_mov_b32 s26, 256
    s_mov_b32 s27, 0x20000
    s_mov_b32 s28, s62
    s_and_b32 s29, s63, 0xffff
    s_mov_b32 s30, 32768
    s_mov_b32 s31, 0x20000
    s_load_dwordx4 s[36:39], s[50:51], 0
    s_load_dwordx2 s[40:41], s[50:51], 16
    s_load_dword s42, s[50:51], 24
    s_load_dword s43, s[52:53], 0
    s_load_dword s76, s[60:61], 0
    s_lshl_b32 s77, s3, 6
    s_add_u32 s56, s56, s77
    s_addc_u32 s57, s57, 0
    s_add_u32 s58, s58, s77
    s_addc_u32 s59, s59, 0
    s_load_dwordx16 s[60:75], s[58:59], 0
    s_load_dwordx16 s[44:59], s[56:57], 0
    v_lshrrev_b32 v7, 4, v1
    v_xor_b32 v2, v2, v7
    v_lshlrev_b32 v2, 4, v2
    v_lshlrev_b32 v5, 4, v1
    v_bfe_u32 v6, v1, 2, 2
    v_lshrrev_b32 v8, 5, v1
    v_xor_b32 v23, v6, v8
    v_lshlrev_b32 v23, 4, v23
    v_and_b32 v11, 31, v1
    v_lshl_add_u32 v9, v11, 6, v23
    v_xor_b32 v10, 32, v9
    v_add_u32 v11, 61440, v9
    v_add_u32 v12, 61440, v10
    v_add_u32 v13, 122880, v9
    v_add_u32 v14, 122880, v10
    v_lshl_add_u32 v15, v8, 3, v6
    v_lshlrev_b32 v15, 8, v15
    v_and_b32 v23, 1, v7
    v_lshlrev_b32 v23, 1, v23
    v_bfe_u32 v7, v1, 1, 1
    v_add_u32 v23, v23, v7
    s_lshl_b32 s77, s3, 2
    v_add_u32 v23, s77, v23
    v_lshlrev_b32 v6, 2, v6
    v_xor_b32 v23, v23, v6
    v_lshl_add_u32 v15, v23, 4, v15
    v_and_b32 v23, 1, v1
    v_lshl_add_u32 v15, v23, 3, v15
    v_add_u32 v16, 40960, v15
    v_add_u32 v17, 81920, v15
    s_lshl_b32 s93, s2, 14
    s_lshl_b32 s95, s3, 12
    s_add_u32 s93, s93, s95
    s_xor_b32 s95, s93, 16384
    s_bitcmp1_b32 s2, 3
    s_cbranch_scc0 L_noearly
    s_waitcnt vmcnt(3)
    v_lshlrev_b32 v72, 6, v72
    v_lshlrev_b32 v73, 6, v73
    v_lshlrev_b32 v74, 6, v74
    v_lshlrev_b32 v75, 6, v75
    v_lshlrev_b32 v76, 6, v76
    v_lshlrev_b32 v77, 6, v77
    v_lshlrev_b32 v78, 6, v78
    v_lshlrev_b32 v79, 6, v79
    v_lshlrev_b32 v80, 6, v80
    v_lshlrev_b32 v81, 6, v81
    v_lshlrev_b32 v82, 6, v82
    v_lshlrev_b32 v83, 6, v83
    v_lshlrev_b32 v84, 6, v84
    v_lshlrev_b32 v85, 6, v85
    s_nop 1
    s_add_u32 m0, s7, 122880
    v_add_u32_dpp v6, v72, v2 quad_perm:[0,0,0,0] row_mask:0xf bank_mask:0xf
    buffer_load_dwordx4 v6, s[12:15], 0 offen lds
    s_add_u32 m0, s7, 126976
    v_add_u32_dpp v7, v73, v2 quad_perm:[0,0,0,0] row_mask:0xf bank_mask:0xf
    buffer_load_dwordx4 v7, s[12:15], 0 offen lds
    s_add_u32 m0, s7, 131072
    v_add_u32_dpp v6, v74, v2 quad_perm:[0,0,0,0] row_mask:0xf bank_mask:0xf
    buffer_load_dwordx4 v6, s[12:15], 0 offen lds
    s_add_u32 m0, s7, 135168
    v_add_u32_dpp v7, v75, v2 quad_perm:[0,0,0,0] row_mask:0xf bank_mask:0xf
    buffer_load_dwordx4 v7, s[12:15], 0 offen lds
    s_add_u32 m0, s7, 139264
    v_add_u32_dpp v6, v72, v2 quad_perm:[1,1,1,1] row_mask:0xf bank_mask:0xf
    buffer_load_dwordx4 v6, s[12:15], 0 offen lds
    s_add_u32 m0, s7, 143360
    v_add_u32_dpp v7, v73, v2 quad_perm:[1,1,1,1] row_mask:0xf bank_mask:0xf
    buffer_load_dwordx4 v7, s[12:15], 0 offen lds
    s_add_u32 m0, s7, 147456
    v_add_u32_dpp v6, v74, v2 quad_perm:[1,1,1,1] row_mask:0xf bank_mask:0xf
    buffer_load_dwordx4 v6, s[12:15], 0 offen lds
    s_add_u32 m0, s7, 151552
    v_add_u32_dpp v7, v75, v2 quad_perm:[1,1,1,1] row_mask:0xf bank_mask:0xf
    buffer_load_dwordx4 v7, s[12:15], 0 offen lds
    s_add_u32 m0, s7, 155648
    v_add_u32_dpp v6, v72, v2 quad_perm:[2,2,2,2] row_mask:0xf bank_mask:0xf
    buffer_load_dwordx4 v6, s[12:15], 0 offen lds
    s_add_u32 m0, s7, 159744
    v_add_u32_dpp v7, v73, v2 quad_perm:[2,2,2,2] row_mask:0xf bank_mask:0xf
    buffer_load_dwordx4 v7, s[12:15], 0 offen lds
L_noearly:
    s_add_u32 m0, s92, 0
    s_nop 0
    buffer_load_dwordx4 v4, s[16:19], s6 offen offset:0 lds
    buffer_load_dwordx4 v4, s[16:19], s6 offen offset:1024 lds
    buffer_load_dwordx4 v4, s[16:19], s6 offen offset:2048 lds
    buffer_load_dwordx4 v4, s[16:19], s6 offen offset:3072 lds
    s_add_u32 m0, s92, 4096
    s_add_u32 s77, s6, 4096
    buffer_load_dwordx4 v4, s[16:19], s77 offen offset:0 lds
    buffer_load_dwordx4 v4, s[16:19], s77 offen offset:1024 lds
    buffer_load_dwordx4 v4, s[16:19], s77 offen offset:2048 lds
    buffer_load_dwordx4 v4, s[16:19], s77 offen offset:3072 lds
    s_add_u32 m0, s92, 8192
    s_add_u32 s77, s6, 8192
    buffer_load_dwordx4 v4, s[16:19], s77 offen offset:0 lds
    buffer_load_dwordx4 v4, s[16:19], s77 offen offset:1024 lds
    s_add_u32 s6, s6, 40960
    s_add_u32 m0, s92, 40960
    s_nop 0
    buffer_load_dwordx4 v4, s[16:19], s6 offen offset:0 lds
    buffer_load_dwordx4 v4, s[16:19], s6 offen offset:1024 lds
    buffer_load_dwordx4 v4, s[16:19], s6 offen offset:2048 lds
    buffer_load_dwordx4 v4, s[16:19], s6 offen offset:3072 lds
    s_add_u32 m0, s92, 45056
    s_add_u32 s77, s6, 4096
    buffer_load_dwordx4 v4, s[16:19], s77 offen offset:0 lds
    buffer_load_dwordx4 v4, s[16:19], s77 offen offset:1024 lds
    buffer_load_dwordx4 v4, s[16:19], s77 offen offset:2048 lds
    buffer_load_dwordx4 v4, s[16:19], s77 offen offset:3072 lds
    s_add_u32 m0, s92, 49152
    s_add_u32 s77, s6, 8192
    buffer_load_dwordx4 v4, s[16:19], s77 offen offset:0 lds
    buffer_load_dwordx4 v4, s[16:19], s77 offen offset:1024 lds
    s_add_u32 s6, s6, 40960
    s_waitcnt lgkmcnt(0)
    s_lshl_b32 s78, s36, 16
    s_and_b32 s79, s36, 0xffff0000
    s_lshl_b32 s80, s37, 16
    s_and_b32 s81, s37, 0xffff0000
    s_lshl_b32 s82, s38, 16
    s_and_b32 s83, s38, 0xffff0000
    s_lshl_b32 s84, s39, 16
    s_and_b32 s85, s39, 0xffff0000
    s_lshl_b32 s86, s40, 16
    s_and_b32 s87, s40, 0xffff0000
    s_lshl_b32 s88, s41, 16
    s_and_b32 s89, s41, 0xffff0000
    s_lshl_b32 s90, s42, 16
    s_lshl_b32 s43, s43, 16
    s_lshl_b32 s76, s76, 16
    v_mov_b32 v22, s43
    v_add_f32 v22, s76, v22
    s_lshl_b32 s77, s44, 16
    v_mov_b32 v24, s77
    s_and_b32 s77, s44, 0xffff0000
    v_mov_b32 v25, s77
    s_lshl_b32 s77, s45, 16
    v_mov_b32 v26, s77
    s_and_b32 s77, s45, 0xffff0000
    v_mov_b32 v27, s77
    s_lshl_b32 s77, s48, 16
    v_mov_b32 v28, s77
    s_and_b32 s77, s48, 0xffff0000
    v_mov_b32 v29, s77
    s_lshl_b32 s77, s49, 16
    v_mov_b32 v30, s77
    s_and_b32 s77, s49, 0xffff0000
    v_mov_b32 v31, s77
    s_lshl_b32 s77, s52, 16
    v_mov_b32 v32, s77
    s_and_b32 s77, s52, 0xffff0000
    v_mov_b32 v33, s77
    s_lshl_b32 s77, s53, 16
    v_mov_b32 v34, s77
    s_and_b32 s77, s53, 0xffff0000
    v_mov_b32 v35, s77
    s_lshl_b32 s77, s56, 16
    v_mov_b32 v36, s77
    s_and_b32 s77, s56, 0xffff0000
    v_mov_b32 v37, s77
    s_lshl_b32 s77, s57, 16
    v_mov_b32 v38, s77
    s_and_b32 s77, s57, 0xffff0000
    v_mov_b32 v39, s77
    s_mov_b32 exec_lo, 0
    s_lshl_b32 s77, s46, 16
    v_mov_b32 v24, s77
    s_and_b32 s77, s46, 0xffff0000
    v_mov_b32 v25, s77
    s_lshl_b32 s77, s47, 16
    v_mov_b32 v26, s77
    s_and_b32 s77, s47, 0xffff0000
    v_mov_b32 v27, s77
    s_lshl_b32 s77, s50, 16
    v_mov_b32 v28, s77
    s_and_b32 s77, s50, 0xffff0000
    v_mov_b32 v29, s77
    s_lshl_b32 s77, s51, 16
    v_mov_b32 v30, s77
    s_and_b32 s77, s51, 0xffff0000
    v_mov_b32 v31, s77
    s_lshl_b32 s77, s54, 16
    v_mov_b32 v32, s77
    s_and_b32 s77, s54, 0xffff0000
    v_mov_b32 v33, s77
    s_lshl_b32 s77, s55, 16
    v_mov_b32 v34, s77
    s_and_b32 s77, s55, 0xffff0000
    v_mov_b32 v35, s77
    s_lshl_b32 s77, s58, 16
    v_mov_b32 v36, s77
    s_and_b32 s77, s58, 0xffff0000
    v_mov_b32 v37, s77
    s_lshl_b32 s77, s59, 16
    v_mov_b32 v38, s77
    s_and_b32 s77, s59, 0xffff0000
    v_mov_b32 v39, s77
    s_mov_b32 exec_lo, -1
    v_mov_b32 v40, v24
    v_mov_b32 v41, v25
    v_mov_b32 v42, v26
    v_mov_b32 v43, v27
    v_mov_b32 v44, v28
    v_mov_b32 v45, v29
    v_mov_b32 v46, v30
    v_mov_b32 v47, v31
    v_mov_b32 v48, v32
    v_mov_b32 v49, v33
    v_mov_b32 v50, v34
    v_mov_b32 v51, v35
    v_mov_b32 v52, v36
    v_mov_b32 v53, v37
    v_mov_b32 v54, v38
    v_mov_b32 v55, v39
    s_waitcnt vmcnt(10)
    s_barrier
    ds_read_b64_tr_b16 v[112:113], v15 offset:0
    ds_read_b64_tr_b16 v[114:115], v15 offset:1024
    ds_read_b64_tr_b16 v[116:117], v15 offset:4096
    ds_read_b64_tr_b16 v[118:119], v15 offset:5120
    ds_read_b64_tr_b16 v[120:121], v15 offset:8192
    ds_read_b64_tr_b16 v[122:123], v15 offset:9216
    ds_read_b64_tr_b16 v[124:125], v15 offset:12288
    ds_read_b64_tr_b16 v[126:127], v15 offset:13312
    ds_read_b64_tr_b16 v[128:129], v15 offset:16384
    ds_read_b64_tr_b16 v[130:131], v15 offset:17408
    ds_read_b64_tr_b16 v[132:133], v15 offset:20480
    ds_read_b64_tr_b16 v[134:135], v15 offset:21504
    s_waitcnt lgkmcnt(4)
    ds_read_b64_tr_b16 v[136:137], v15 offset:24576
    ds_read_b64_tr_b16 v[138:139], v15 offset:25600
    ds_read_b64_tr_b16 v[140:141], v15 offset:28672
    ds_read_b64_tr_b16 v[142:143], v15 offset:29696
    ds_read_b64_tr_b16 v[144:145], v15 offset:32768
    ds_read_b64_tr_b16 v[146:147], v15 offset:33792
    ds_read_b64_tr_b16 v[148:149], v15 offset:36864
    ds_read_b64_tr_b16 v[150:151], v15 offset:37888
    s_add_u32 m0, s92, 81920
    s_nop 0
    buffer_load_dwordx4 v4, s[16:19], s6 offen offset:0 lds
    buffer_load_dwordx4 v4, s[16:19], s6 offen offset:1024 lds
    buffer_load_dwordx4 v4, s[16:19], s6 offen offset:2048 lds
    buffer_load_dwordx4 v4, s[16:19], s6 offen offset:3072 lds
    s_add_u32 m0, s92, 86016
    s_add_u32 s77, s6, 4096
    buffer_load_dwordx4 v4, s[16:19], s77 offen offset:0 lds
    buffer_load_dwordx4 v4, s[16:19], s77 offen offset:1024 lds
    buffer_load_dwordx4 v4, s[16:19], s77 offen offset:2048 lds
    buffer_load_dwordx4 v4, s[16:19], s77 offen offset:3072 lds
    s_add_u32 m0, s92, 90112
    s_add_u32 s77, s6, 8192
    buffer_load_dwordx4 v4, s[16:19], s77 offen offset:0 lds
    buffer_load_dwordx4 v4, s[16:19], s77 offen offset:1024 lds
    s_add_u32 s6, s6, 40960
    s_waitcnt lgkmcnt(0)
    s_waitcnt vmcnt(10)
    s_barrier
    ds_read_b64_tr_b16 v[152:153], v16 offset:0
    ds_read_b64_tr_b16 v[154:155], v16 offset:1024
    ds_read_b64_tr_b16 v[156:157], v16 offset:4096
    ds_read_b64_tr_b16 v[158:159], v16 offset:5120
    ds_read_b64_tr_b16 v[160:161], v16 offset:8192
    ds_read_b64_tr_b16 v[162:163], v16 offset:9216
    ds_read_b64_tr_b16 v[164:165], v16 offset:12288
    ds_read_b64_tr_b16 v[166:167], v16 offset:13312
    ds_read_b64_tr_b16 v[168:169], v16 offset:16384
    ds_read_b64_tr_b16 v[170:171], v16 offset:17408
    ds_read_b64_tr_b16 v[172:173], v16 offset:20480
    ds_read_b64_tr_b16 v[174:175], v16 offset:21504
    s_waitcnt lgkmcnt(4)
    ds_read_b64_tr_b16 v[176:177], v16 offset:24576
    ds_read_b64_tr_b16 v[178:179], v16 offset:25600
    ds_read_b64_tr_b16 v[180:181], v16 offset:28672
    ds_read_b64_tr_b16 v[182:183], v16 offset:29696
    ds_read_b64_tr_b16 v[184:185], v16 offset:32768
    ds_read_b64_tr_b16 v[186:187], v16 offset:33792
    ds_read_b64_tr_b16 v[188:189], v16 offset:36864
    ds_read_b64_tr_b16 v[190:191], v16 offset:37888
    s_add_u32 m0, s92, 0
    s_nop 0
    buffer_load_dwordx4 v4, s[16:19], s6 offen offset:0 lds
    buffer_load_dwordx4 v4, s[16:19], s6 offen offset:1024 lds
    buffer_load_dwordx4 v4, s[16:19], s6 offen offset:2048 lds
    buffer_load_dwordx4 v4, s[16:19], s6 offen offset:3072 lds
    s_add_u32 m0, s92, 4096
    s_add_u32 s77, s6, 4096
    buffer_load_dwordx4 v4, s[16:19], s77 offen offset:0 lds
    buffer_load_dwordx4 v4, s[16:19], s77 offen offset:1024 lds
    buffer_load_dwordx4 v4, s[16:19], s77 offen offset:2048 lds
    buffer_load_dwordx4 v4, s[16:19], s77 offen offset:3072 lds
    s_add_u32 m0, s92, 8192
    s_add_u32 s77, s6, 8192
    buffer_load_dwordx4 v4, s[16:19], s77 offen offset:0 lds
    buffer_load_dwordx4 v4, s[16:19], s77 offen offset:1024 lds
    s_add_u32 s6, s6, 40960
    s_waitcnt lgkmcnt(0)
    s_waitcnt vmcnt(10)
    s_bitcmp1_b32 s2, 3
    s_cbranch_scc1 L_noshift
    v_lshlrev_b32 v72, 6, v72
    v_lshlrev_b32 v73, 6, v73
    v_lshlrev_b32 v74, 6, v74
    v_lshlrev_b32 v75, 6, v75
    v_lshlrev_b32 v76, 6, v76
    v_lshlrev_b32 v77, 6, v77
    v_lshlrev_b32 v78, 6, v78
    v_lshlrev_b32 v79, 6, v79
    v_lshlrev_b32 v80, 6, v80
    v_lshlrev_b32 v81, 6, v81
    v_lshlrev_b32 v82, 6, v82
    v_lshlrev_b32 v83, 6, v83
    v_lshlrev_b32 v84, 6, v84
    v_lshlrev_b32 v85, 6, v85
L_noshift:
    v_mov_b32 v21, v22
    v_lshlrev_b32 v6, 16, v64
    v_fmac_f32 v21, s78, v6
    v_and_b32 v6, 0xffff0000, v64
    v_fmac_f32 v21, s79, v6
    v_lshlrev_b32 v6, 16, v65
    v_fmac_f32 v21, s80, v6
    v_and_b32 v6, 0xffff0000, v65
    v_fmac_f32 v21, s81, v6
    v_lshlrev_b32 v6, 16, v66
    v_fmac_f32 v21, s82, v6
    v_and_b32 v6, 0xffff0000, v66
    v_fmac_f32 v21, s83, v6
    v_lshlrev_b32 v6, 16, v67
    v_fmac_f32 v21, s84, v6
    v_and_b32 v6, 0xffff0000, v67
    v_fmac_f32 v21, s85, v6
    v_lshlrev_b32 v6, 16, v68
    v_fmac_f32 v21, s86, v6
    v_and_b32 v6, 0xffff0000, v68
    v_fmac_f32 v21, s87, v6
    v_lshlrev_b32 v6, 16, v69
    v_fmac_f32 v21, s88, v6
    v_and_b32 v6, 0xffff0000, v69
    v_fmac_f32 v21, s89, v6
    v_lshlrev_b32 v6, 16, v70
    v_fmac_f32 v21, s90, v6
    s_barrier
    ds_read_b64_tr_b16 v[192:193], v17 offset:0
    ds_read_b64_tr_b16 v[194:195], v17 offset:1024
    ds_read_b64_tr_b16 v[196:197], v17 offset:4096
    ds_read_b64_tr_b16 v[198:199], v17 offset:5120
    ds_read_b64_tr_b16 v[200:201], v17 offset:8192
    ds_read_b64_tr_b16 v[202:203], v17 offset:9216
    ds_read_b64_tr_b16 v[204:205], v17 offset:12288
    ds_read_b64_tr_b16 v[206:207], v17 offset:13312
    ds_read_b64_tr_b16 v[208:209], v17 offset:16384
    ds_read_b64_tr_b16 v[210:211], v17 offset:17408
    ds_read_b64_tr_b16 v[212:213], v17 offset:20480
    ds_read_b64_tr_b16 v[214:215], v17 offset:21504
    s_waitcnt lgkmcnt(4)
    ds_read_b64_tr_b16 v[216:217], v17 offset:24576
    ds_read_b64_tr_b16 v[218:219], v17 offset:25600
    ds_read_b64_tr_b16 v[220:221], v17 offset:28672
    ds_read_b64_tr_b16 v[222:223], v17 offset:29696
    ds_read_b64_tr_b16 v[224:225], v17 offset:32768
    ds_read_b64_tr_b16 v[226:227], v17 offset:33792
    ds_read_b64_tr_b16 v[228:229], v17 offset:36864
    ds_read_b64_tr_b16 v[230:231], v17 offset:37888
    s_add_u32 m0, s92, 40960
    s_nop 0
    buffer_load_dwordx4 v4, s[16:19], s6 offen offset:0 lds
    buffer_load_dwordx4 v4, s[16:19], s6 offen offset:1024 lds
    buffer_load_dwordx4 v4, s[16:19], s6 offen offset:2048 lds
    buffer_load_dwordx4 v4, s[16:19], s6 offen offset:3072 lds
    s_add_u32 m0, s92, 45056
    s_add_u32 s77, s6, 4096
    buffer_load_dwordx4 v4, s[16:19], s77 offen offset:0 lds
    buffer_load_dwordx4 v4, s[16:19], s77 offen offset:1024 lds
    buffer_load_dwordx4 v4, s[16:19], s77 offen offset:2048 lds
    buffer_load_dwordx4 v4, s[16:19], s77 offen offset:3072 lds
    s_add_u32 m0, s92, 49152
    s_add_u32 s77, s6, 8192
    buffer_load_dwordx4 v4, s[16:19], s77 offen offset:0 lds
    buffer_load_dwordx4 v4, s[16:19], s77 offen offset:1024 lds
    s_add_u32 s6, s6, 40960
    s_waitcnt lgkmcnt(0)
    s_waitcnt vmcnt(10)
    s_barrier
    ds_read_b64_tr_b16 v[232:233], v15 offset:0
    ds_read_b64_tr_b16 v[234:235], v15 offset:1024
    ds_read_b64_tr_b16 v[236:237], v15 offset:4096
    ds_read_b64_tr_b16 v[238:239], v15 offset:5120
    ds_read_b64_tr_b16 v[240:241], v15 offset:8192
    ds_read_b64_tr_b16 v[242:243], v15 offset:9216
    ds_read_b64_tr_b16 v[244:245], v15 offset:12288
    ds_read_b64_tr_b16 v[246:247], v15 offset:13312
    ds_read_b64_tr_b16 v[248:249], v15 offset:16384
    ds_read_b64_tr_b16 v[250:251], v15 offset:17408
    ds_read_b64_tr_b16 v[252:253], v15 offset:20480
    ds_read_b64_tr_b16 v[254:255], v15 offset:21504
    s_waitcnt lgkmcnt(4)
    ds_read_b64_tr_b16 a[0:1], v15 offset:24576
    ds_read_b64_tr_b16 a[2:3], v15 offset:25600
    ds_read_b64_tr_b16 a[4:5], v15 offset:28672
    ds_read_b64_tr_b16 a[6:7], v15 offset:29696
    ds_read_b64_tr_b16 a[8:9], v15 offset:32768
    ds_read_b64_tr_b16 a[10:11], v15 offset:33792
    ds_read_b64_tr_b16 a[12:13], v15 offset:36864
    ds_read_b64_tr_b16 a[14:15], v15 offset:37888
    s_add_u32 m0, s92, 81920
    s_nop 0
    buffer_load_dwordx4 v4, s[16:19], s6 offen offset:0 lds
    buffer_load_dwordx4 v4, s[16:19], s6 offen offset:1024 lds
    buffer_load_dwordx4 v4, s[16:19], s6 offen offset:2048 lds
    buffer_load_dwordx4 v4, s[16:19], s6 offen offset:3072 lds
    s_add_u32 m0, s92, 86016
    s_add_u32 s77, s6, 4096
    buffer_load_dwordx4 v4, s[16:19], s77 offen offset:0 lds
    buffer_load_dwordx4 v4, s[16:19], s77 offen offset:1024 lds
    buffer_load_dwordx4 v4, s[16:19], s77 offen offset:2048 lds
    buffer_load_dwordx4 v4, s[16:19], s77 offen offset:3072 lds
    s_add_u32 m0, s92, 90112
    s_add_u32 s77, s6, 8192
    buffer_load_dwordx4 v4, s[16:19], s77 offen offset:0 lds
    buffer_load_dwordx4 v4, s[16:19], s77 offen offset:1024 lds
    s_add_u32 s6, s6, 40960
    s_waitcnt lgkmcnt(0)
    s_waitcnt vmcnt(10)
    s_barrier
    ds_read_b64_tr_b16 a[16:17], v16 offset:0
    ds_read_b64_tr_b16 a[18:19], v16 offset:1024
    ds_read_b64_tr_b16 a[20:21], v16 offset:4096
    ds_read_b64_tr_b16 a[22:23], v16 offset:5120
    ds_read_b64_tr_b16 a[24:25], v16 offset:8192
    ds_read_b64_tr_b16 a[26:27], v16 offset:9216
    ds_read_b64_tr_b16 a[28:29], v16 offset:12288
    ds_read_b64_tr_b16 a[30:31], v16 offset:13312
    ds_read_b64_tr_b16 a[32:33], v16 offset:16384
    ds_read_b64_tr_b16 a[34:35], v16 offset:17408
    ds_read_b64_tr_b16 a[36:37], v16 offset:20480
    ds_read_b64_tr_b16 a[38:39], v16 offset:21504
    s_waitcnt lgkmcnt(4)
    ds_read_b64_tr_b16 a[40:41], v16 offset:24576
    ds_read_b64_tr_b16 a[42:43], v16 offset:25600
    ds_read_b64_tr_b16 a[44:45], v16 offset:28672
    ds_read_b64_tr_b16 a[46:47], v16 offset:29696
    ds_read_b64_tr_b16 a[48:49], v16 offset:32768
    ds_read_b64_tr_b16 a[50:51], v16 offset:33792
    ds_read_b64_tr_b16 a[52:53], v16 offset:36864
    ds_read_b64_tr_b16 a[54:55], v16 offset:37888
    s_add_u32 m0, s92, 0
    s_nop 0
    buffer_load_dwordx4 v4, s[16:19], s6 offen offset:0 lds
    buffer_load_dwordx4 v4, s[16:19], s6 offen offset:1024 lds
    buffer_load_dwordx4 v4, s[16:19], s6 offen offset:2048 lds
    buffer_load_dwordx4 v4, s[16:19], s6 offen offset:3072 lds
    s_add_u32 m0, s92, 4096
    s_add_u32 s77, s6, 4096
    buffer_load_dwordx4 v4, s[16:19], s77 offen offset:0 lds
    buffer_load_dwordx4 v4, s[16:19], s77 offen offset:1024 lds
    buffer_load_dwordx4 v4, s[16:19], s77 offen offset:2048 lds
    buffer_load_dwordx4 v4, s[16:19], s77 offen offset:3072 lds
    s_add_u32 m0, s92, 8192
    s_add_u32 s77, s6, 8192
    buffer_load_dwordx4 v4, s[16:19], s77 offen offset:0 lds
    buffer_load_dwordx4 v4, s[16:19], s77 offen offset:1024 lds
    s_add_u32 s6, s6, 40960
    s_waitcnt lgkmcnt(0)
    s_waitcnt vmcnt(10)
    s_barrier
    ds_read_b64_tr_b16 a[56:57], v17 offset:0
    ds_read_b64_tr_b16 a[58:59], v17 offset:1024
    ds_read_b64_tr_b16 a[60:61], v17 offset:4096
    ds_read_b64_tr_b16 a[62:63], v17 offset:5120
    ds_read_b64_tr_b16 a[64:65], v17 offset:8192
    ds_read_b64_tr_b16 a[66:67], v17 offset:9216
    ds_read_b64_tr_b16 a[68:69], v17 offset:12288
    ds_read_b64_tr_b16 a[70:71], v17 offset:13312
    ds_read_b64_tr_b16 a[72:73], v17 offset:16384
    ds_read_b64_tr_b16 a[74:75], v17 offset:17408
    ds_read_b64_tr_b16 a[76:77], v17 offset:20480
    ds_read_b64_tr_b16 a[78:79], v17 offset:21504
    s_waitcnt lgkmcnt(4)
    ds_read_b64_tr_b16 a[80:81], v17 offset:24576
    ds_read_b64_tr_b16 a[82:83], v17 offset:25600
    ds_read_b64_tr_b16 a[84:85], v17 offset:28672
    ds_read_b64_tr_b16 a[86:87], v17 offset:29696
    ds_read_b64_tr_b16 a[88:89], v17 offset:32768
    ds_read_b64_tr_b16 a[90:91], v17 offset:33792
    ds_read_b64_tr_b16 a[92:93], v17 offset:36864
    ds_read_b64_tr_b16 a[94:95], v17 offset:37888
    s_add_u32 m0, s92, 40960
    s_nop 0
    buffer_load_dwordx4 v4, s[16:19], s6 offen offset:0 lds
    buffer_load_dwordx4 v4, s[16:19], s6 offen offset:1024 lds
    buffer_load_dwordx4 v4, s[16:19], s6 offen offset:2048 lds
    buffer_load_dwordx4 v4, s[16:19], s6 offen offset:3072 lds
    s_add_u32 m0, s92, 45056
    s_add_u32 s77, s6, 4096
    buffer_load_dwordx4 v4, s[16:19], s77 offen offset:0 lds
    buffer_load_dwordx4 v4, s[16:19], s77 offen offset:1024 lds
    buffer_load_dwordx4 v4, s[16:19], s77 offen offset:2048 lds
    buffer_load_dwordx4 v4, s[16:19], s77 offen offset:3072 lds
    s_add_u32 m0, s92, 49152
    s_add_u32 s77, s6, 8192
    buffer_load_dwordx4 v4, s[16:19], s77 offen offset:0 lds
    buffer_load_dwordx4 v4, s[16:19], s77 offen offset:1024 lds
    s_add_u32 s6, s6, 40960
    s_waitcnt lgkmcnt(0)
    s_waitcnt vmcnt(10)
    s_barrier
    ds_read_b64_tr_b16 a[96:97], v15 offset:0
    ds_read_b64_tr_b16 a[98:99], v15 offset:1024
    ds_read_b64_tr_b16 a[100:101], v15 offset:4096
    ds_read_b64_tr_b16 a[102:103], v15 offset:5120
    ds_read_b64_tr_b16 a[104:105], v15 offset:8192
    ds_read_b64_tr_b16 a[106:107], v15 offset:9216
    ds_read_b64_tr_b16 a[108:109], v15 offset:12288
    ds_read_b64_tr_b16 a[110:111], v15 offset:13312
    ds_read_b64_tr_b16 a[112:113], v15 offset:16384
    ds_read_b64_tr_b16 a[114:115], v15 offset:17408
    ds_read_b64_tr_b16 a[116:117], v15 offset:20480
    ds_read_b64_tr_b16 a[118:119], v15 offset:21504
    s_waitcnt lgkmcnt(4)
    ds_read_b64_tr_b16 a[120:121], v15 offset:24576
    ds_read_b64_tr_b16 a[122:123], v15 offset:25600
    ds_read_b64_tr_b16 a[124:125], v15 offset:28672
    ds_read_b64_tr_b16 a[126:127], v15 offset:29696
    ds_read_b64_tr_b16 a[128:129], v15 offset:32768
    ds_read_b64_tr_b16 a[130:131], v15 offset:33792
    ds_read_b64_tr_b16 a[132:133], v15 offset:36864
    ds_read_b64_tr_b16 a[134:135], v15 offset:37888
    s_add_u32 m0, s92, 81920
    s_nop 0
    buffer_load_dwordx4 v4, s[16:19], s6 offen offset:0 lds
    buffer_load_dwordx4 v4, s[16:19], s6 offen offset:1024 lds
    buffer_load_dwordx4 v4, s[16:19], s6 offen offset:2048 lds
    buffer_load_dwordx4 v4, s[16:19], s6 offen offset:3072 lds
    s_add_u32 m0, s92, 86016
    s_add_u32 s77, s6, 4096
    buffer_load_dwordx4 v4, s[16:19], s77 offen offset:0 lds
    buffer_load_dwordx4 v4, s[16:19], s77 offen offset:1024 lds
    buffer_load_dwordx4 v4, s[16:19], s77 offen offset:2048 lds
    buffer_load_dwordx4 v4, s[16:19], s77 offen offset:3072 lds
    s_add_u32 m0, s92, 90112
    s_add_u32 s77, s6, 8192
    buffer_load_dwordx4 v4, s[16:19], s77 offen offset:0 lds
    buffer_load_dwordx4 v4, s[16:19], s77 offen offset:1024 lds
    s_add_u32 s6, s6, 40960
    s_waitcnt lgkmcnt(0)
    s_waitcnt vmcnt(10)
    s_barrier
    ds_read_b64_tr_b16 a[136:137], v16 offset:0
    ds_read_b64_tr_b16 a[138:139], v16 offset:1024
    ds_read_b64_tr_b16 a[140:141], v16 offset:4096
    ds_read_b64_tr_b16 a[142:143], v16 offset:5120
    ds_read_b64_tr_b16 a[144:145], v16 offset:8192
    ds_read_b64_tr_b16 a[146:147], v16 offset:9216
    ds_read_b64_tr_b16 a[148:149], v16 offset:12288
    ds_read_b64_tr_b16 a[150:151], v16 offset:13312
    ds_read_b64_tr_b16 a[152:153], v16 offset:16384
    ds_read_b64_tr_b16 a[154:155], v16 offset:17408
    ds_read_b64_tr_b16 a[156:157], v16 offset:20480
    ds_read_b64_tr_b16 a[158:159], v16 offset:21504
    s_waitcnt lgkmcnt(4)
    ds_read_b64_tr_b16 a[160:161], v16 offset:24576
    ds_read_b64_tr_b16 a[162:163], v16 offset:25600
    ds_read_b64_tr_b16 a[164:165], v16 offset:28672
    ds_read_b64_tr_b16 a[166:167], v16 offset:29696
    ds_read_b64_tr_b16 a[168:169], v16 offset:32768
    ds_read_b64_tr_b16 a[170:171], v16 offset:33792
    ds_read_b64_tr_b16 a[172:173], v16 offset:36864
    ds_read_b64_tr_b16 a[174:175], v16 offset:37888
    s_add_u32 m0, s92, 0
    s_nop 0
    buffer_load_dwordx4 v4, s[16:19], s6 offen offset:0 lds
    buffer_load_dwordx4 v4, s[16:19], s6 offen offset:1024 lds
    buffer_load_dwordx4 v4, s[16:19], s6 offen offset:2048 lds
    buffer_load_dwordx4 v4, s[16:19], s6 offen offset:3072 lds
    s_add_u32 m0, s92, 4096
    s_add_u32 s77, s6, 4096
    buffer_load_dwordx4 v4, s[16:19], s77 offen offset:0 lds
    buffer_load_dwordx4 v4, s[16:19], s77 offen offset:1024 lds
    buffer_load_dwordx4 v4, s[16:19], s77 offen offset:2048 lds
    buffer_load_dwordx4 v4, s[16:19], s77 offen offset:3072 lds
    s_add_u32 m0, s92, 8192
    s_add_u32 s77, s6, 8192
    buffer_load_dwordx4 v4, s[16:19], s77 offen offset:0 lds
    buffer_load_dwordx4 v4, s[16:19], s77 offen offset:1024 lds
    s_add_u32 s6, s6, 40960
    s_waitcnt lgkmcnt(0)
    s_waitcnt vmcnt(10)
    s_barrier
    ds_read_b64_tr_b16 a[176:177], v17 offset:0
    ds_read_b64_tr_b16 a[178:179], v17 offset:1024
    ds_read_b64_tr_b16 a[180:181], v17 offset:4096
    ds_read_b64_tr_b16 a[182:183], v17 offset:5120
    ds_read_b64_tr_b16 a[184:185], v17 offset:8192
    ds_read_b64_tr_b16 a[186:187], v17 offset:9216
    ds_read_b64_tr_b16 a[188:189], v17 offset:12288
    ds_read_b64_tr_b16 a[190:191], v17 offset:13312
    ds_read_b64_tr_b16 a[192:193], v17 offset:16384
    ds_read_b64_tr_b16 a[194:195], v17 offset:17408
    ds_read_b64_tr_b16 a[196:197], v17 offset:20480
    ds_read_b64_tr_b16 a[198:199], v17 offset:21504
    s_waitcnt lgkmcnt(4)
    ds_read_b64_tr_b16 a[200:201], v17 offset:24576
    ds_read_b64_tr_b16 a[202:203], v17 offset:25600
    ds_read_b64_tr_b16 a[204:205], v17 offset:28672
    ds_read_b64_tr_b16 a[206:207], v17 offset:29696
    ds_read_b64_tr_b16 a[208:209], v17 offset:32768
    ds_read_b64_tr_b16 a[210:211], v17 offset:33792
    ds_read_b64_tr_b16 a[212:213], v17 offset:36864
    ds_read_b64_tr_b16 a[214:215], v17 offset:37888
    v_mov_b32 v6, 0
    v_mov_b32 v7, 0
    s_bitcmp1_b32 s2, 3
    s_cselect_b64 exec, 0, -1
    s_add_u32 m0, s7, 122880
    v_add_u32_dpp v6, v72, v2 quad_perm:[0,0,0,0] row_mask:0xf bank_mask:0xf
    buffer_load_dwordx4 v6, s[12:15], 0 offen lds
    s_add_u32 m0, s7, 126976
    v_add_u32_dpp v7, v73, v2 quad_perm:[0,0,0,0] row_mask:0xf bank_mask:0xf
    buffer_load_dwordx4 v7, s[12:15], 0 offen lds
    s_add_u32 m0, s7, 131072
    v_add_u32_dpp v6, v74, v2 quad_perm:[0,0,0,0] row_mask:0xf bank_mask:0xf
    buffer_load_dwordx4 v6, s[12:15], 0 offen lds
    s_add_u32 m0, s7, 135168
    v_add_u32_dpp v7, v75, v2 quad_perm:[0,0,0,0] row_mask:0xf bank_mask:0xf
    buffer_load_dwordx4 v7, s[12:15], 0 offen lds
    s_add_u32 m0, s7, 139264
    v_add_u32_dpp v6, v72, v2 quad_perm:[1,1,1,1] row_mask:0xf bank_mask:0xf
    buffer_load_dwordx4 v6, s[12:15], 0 offen lds
    s_add_u32 m0, s7, 143360
    v_add_u32_dpp v7, v73, v2 quad_perm:[1,1,1,1] row_mask:0xf bank_mask:0xf
    buffer_load_dwordx4 v7, s[12:15], 0 offen lds
    s_add_u32 m0, s7, 147456
    v_add_u32_dpp v6, v74, v2 quad_perm:[1,1,1,1] row_mask:0xf bank_mask:0xf
    buffer_load_dwordx4 v6, s[12:15], 0 offen lds
    s_add_u32 m0, s7, 151552
    v_add_u32_dpp v7, v75, v2 quad_perm:[1,1,1,1] row_mask:0xf bank_mask:0xf
    buffer_load_dwordx4 v7, s[12:15], 0 offen lds
    s_add_u32 m0, s7, 155648
    v_add_u32_dpp v6, v72, v2 quad_perm:[2,2,2,2] row_mask:0xf bank_mask:0xf
    buffer_load_dwordx4 v6, s[12:15], 0 offen lds
    s_add_u32 m0, s7, 159744
    v_add_u32_dpp v7, v73, v2 quad_perm:[2,2,2,2] row_mask:0xf bank_mask:0xf
    buffer_load_dwordx4 v7, s[12:15], 0 offen lds
    s_mov_b64 exec, -1
    s_waitcnt lgkmcnt(0)
    s_waitcnt vmcnt(10)
    s_barrier
    ds_read_b64_tr_b16 a[216:217], v15 offset:0
    ds_read_b64_tr_b16 a[218:219], v15 offset:1024
    ds_read_b64_tr_b16 a[220:221], v15 offset:4096
    ds_read_b64_tr_b16 a[222:223], v15 offset:5120
    ds_read_b64_tr_b16 a[224:225], v15 offset:8192
    ds_read_b64_tr_b16 a[226:227], v15 offset:9216
    ds_read_b64_tr_b16 a[228:229], v15 offset:12288
    ds_read_b64_tr_b16 a[230:231], v15 offset:13312
    ds_read_b64_tr_b16 a[232:233], v15 offset:16384
    ds_read_b64_tr_b16 a[234:235], v15 offset:17408
    ds_read_b64_tr_b16 a[236:237], v15 offset:20480
    ds_read_b64_tr_b16 a[238:239], v15 offset:21504
    s_waitcnt lgkmcnt(4)
    ds_read_b64_tr_b16 a[240:241], v15 offset:24576
    ds_read_b64_tr_b16 a[242:243], v15 offset:25600
    ds_read_b64_tr_b16 a[244:245], v15 offset:28672
    ds_read_b64_tr_b16 a[246:247], v15 offset:29696
    ds_read_b64_tr_b16 a[248:249], v15 offset:32768
    ds_read_b64_tr_b16 a[250:251], v15 offset:33792
    ds_read_b64_tr_b16 a[252:253], v15 offset:36864
    ds_read_b64_tr_b16 a[254:255], v15 offset:37888
    s_add_u32 m0, s7, 40960
    v_add_u32_dpp v6, v74, v2 quad_perm:[2,2,2,2] row_mask:0xf bank_mask:0xf
    buffer_load_dwordx4 v6, s[12:15], 0 offen lds
    s_add_u32 m0, s7, 45056
    v_add_u32_dpp v7, v75, v2 quad_perm:[2,2,2,2] row_mask:0xf bank_mask:0xf
    buffer_load_dwordx4 v7, s[12:15], 0 offen lds
    s_waitcnt lgkmcnt(0)
    s_lshr_b32 s92, s2, 4
    s_lshl_b32 s92, s92, 3
    s_and_b32 s77, s2, 7
    s_or_b32 s92, s92, s77
    s_lshr_b32 s77, s2, 3
    s_and_b32 s77, s77, 1
    s_lshl_b32 s77, s77, 7
    s_or_b32 s92, s92, s77
    s_waitcnt vmcnt(7)
    s_barrier
    ds_read_b128 v[56:59], v13 offset:0
    ds_read_b128 v[60:63], v13 offset:2048
    ds_read_b128 v[64:67], v14 offset:0
    ds_read_b128 v[68:71], v14 offset:2048
    s_add_u32 m0, s7, 49152
    v_add_u32_dpp v6, v72, v2 quad_perm:[3,3,3,3] row_mask:0xf bank_mask:0xf
    buffer_load_dwordx4 v6, s[12:15], 0 offen lds
    s_waitcnt lgkmcnt(2)
    v_mfma_f32_32x32x16_bf16 v[24:39], v[112:115], v[56:59], v[24:39]
    v_mfma_f32_32x32x16_bf16 v[40:55], v[112:115], v[60:63], v[40:55]
    ds_read_b128 v[56:59], v13 offset:4096
    ds_read_b128 v[60:63], v13 offset:6144
    s_waitcnt lgkmcnt(2)
    v_mfma_f32_32x32x16_bf16 v[24:39], v[116:119], v[64:67], v[24:39]
    v_mfma_f32_32x32x16_bf16 v[40:55], v[116:119], v[68:71], v[40:55]
    ds_read_b128 v[64:67], v14 offset:4096
    ds_read_b128 v[68:71], v14 offset:6144
    s_add_u32 m0, s7, 53248
    v_add_u32_dpp v7, v73, v2 quad_perm:[3,3,3,3] row_mask:0xf bank_mask:0xf
    buffer_load_dwordx4 v7, s[12:15], 0 offen lds
    s_waitcnt lgkmcnt(2)
    v_mfma_f32_32x32x16_bf16 v[24:39], v[120:123], v[56:59], v[24:39]
    v_mfma_f32_32x32x16_bf16 v[40:55], v[120:123], v[60:63], v[40:55]
    ds_read_b128 v[56:59], v13 offset:8192
    ds_read_b128 v[60:63], v13 offset:10240
    s_waitcnt lgkmcnt(2)
    v_mfma_f32_32x32x16_bf16 v[24:39], v[124:127], v[64:67], v[24:39]
    v_mfma_f32_32x32x16_bf16 v[40:55], v[124:127], v[68:71], v[40:55]
    ds_read_b128 v[64:67], v14 offset:8192
    ds_read_b128 v[68:71], v14 offset:10240
    s_add_u32 m0, s7, 57344
    v_add_u32_dpp v6, v74, v2 quad_perm:[3,3,3,3] row_mask:0xf bank_mask:0xf
    buffer_load_dwordx4 v6, s[12:15], 0 offen lds
    s_waitcnt lgkmcnt(2)
    v_mfma_f32_32x32x16_bf16 v[24:39], v[128:131], v[56:59], v[24:39]
    v_mfma_f32_32x32x16_bf16 v[40:55], v[128:131], v[60:63], v[40:55]
    ds_read_b128 v[56:59], v13 offset:12288
    ds_read_b128 v[60:63], v13 offset:14336
    s_waitcnt lgkmcnt(2)
    v_mfma_f32_32x32x16_bf16 v[24:39], v[132:135], v[64:67], v[24:39]
    v_mfma_f32_32x32x16_bf16 v[40:55], v[132:135], v[68:71], v[40:55]
    ds_read_b128 v[64:67], v14 offset:12288
    ds_read_b128 v[68:71], v14 offset:14336
    s_add_u32 m0, s7, 61440
    v_add_u32_dpp v7, v75, v2 quad_perm:[3,3,3,3] row_mask:0xf bank_mask:0xf
    buffer_load_dwordx4 v7, s[12:15], 0 offen lds
    s_waitcnt lgkmcnt(2)
    v_mfma_f32_32x32x16_bf16 v[24:39], v[136:139], v[56:59], v[24:39]
    v_mfma_f32_32x32x16_bf16 v[40:55], v[136:139], v[60:63], v[40:55]
    ds_read_b128 v[56:59], v13 offset:16384
    ds_read_b128 v[60:63], v13 offset:18432
    s_waitcnt lgkmcnt(2)
    v_mfma_f32_32x32x16_bf16 v[24:39], v[140:143], v[64:67], v[24:39]
    v_mfma_f32_32x32x16_bf16 v[40:55], v[140:143], v[68:71], v[40:55]
    ds_read_b128 v[64:67], v14 offset:16384
    ds_read_b128 v[68:71], v14 offset:18432
    s_add_u32 m0, s7, 65536
    v_add_u32_dpp v6, v76, v2 quad_perm:[0,0,0,0] row_mask:0xf bank_mask:0xf
    buffer_load_dwordx4 v6, s[12:15], 0 offen lds
    s_waitcnt lgkmcnt(2)
    v_mfma_f32_32x32x16_bf16 v[24:39], v[144:147], v[56:59], v[24:39]
    v_mfma_f32_32x32x16_bf16 v[40:55], v[144:147], v[60:63], v[40:55]
    s_waitcnt vmcnt(7)
    s_barrier
    ds_read_b128 v[56:59], v13 offset:20480
    ds_read_b128 v[60:63], v13 offset:22528
    s_waitcnt lgkmcnt(2)
    v_mfma_f32_32x32x16_bf16 v[24:39], v[148:151], v[64:67], v[24:39]
    v_mfma_f32_32x32x16_bf16 v[40:55], v[148:151], v[68:71], v[40:55]
    ds_read_b128 v[64:67], v14 offset:20480
    ds_read_b128 v[68:71], v14 offset:22528
    s_add_u32 m0, s7, 69632
    v_add_u32_dpp v7, v77, v2 quad_perm:[0,0,0,0] row_mask:0xf bank_mask:0xf
    buffer_load_dwordx4 v7, s[12:15], 0 offen lds
    s_waitcnt lgkmcnt(2)
    v_mfma_f32_32x32x16_bf16 v[24:39], v[152:155], v[56:59], v[24:39]
    v_mfma_f32_32x32x16_bf16 v[40:55], v[152:155], v[60:63], v[40:55]
    ds_read_b128 v[56:59], v13 offset:24576
    ds_read_b128 v[60:63], v13 offset:26624
    s_waitcnt lgkmcnt(2)
    v_mfma_f32_32x32x16_bf16 v[24:39], v[156:159], v[64:67], v[24:39]
    v_mfma_f32_32x32x16_bf16 v[40:55], v[156:159], v[68:71], v[40:55]
    ds_read_b128 v[64:67], v14 offset:24576
    ds_read_b128 v[68:71], v14 offset:26624
    s_add_u32 m0, s7, 73728
    v_add_u32_dpp v6, v78, v2 quad_perm:[0,0,0,0] row_mask:0xf bank_mask:0xf
    buffer_load_dwordx4 v6, s[12:15], 0 offen lds
    s_waitcnt lgkmcnt(2)
    v_mfma_f32_32x32x16_bf16 v[24:39], v[160:163], v[56:59], v[24:39]
    v_mfma_f32_32x32x16_bf16 v[40:55], v[160:163], v[60:63], v[40:55]
    ds_read_b128 v[56:59], v13 offset:28672
    ds_read_b128 v[60:63], v13 offset:30720
    s_waitcnt lgkmcnt(2)
    v_mfma_f32_32x32x16_bf16 v[24:39], v[164:167], v[64:67], v[24:39]
    v_mfma_f32_32x32x16_bf16 v[40:55], v[164:167], v[68:71], v[40:55]
    ds_read_b128 v[64:67], v14 offset:28672
    ds_read_b128 v[68:71], v14 offset:30720
    s_add_u32 m0, s7, 77824
    v_add_u32_dpp v7, v79, v2 quad_perm:[0,0,0,0] row_mask:0xf bank_mask:0xf
    buffer_load_dwordx4 v7, s[12:15], 0 offen lds
    s_waitcnt lgkmcnt(2)
    v_mfma_f32_32x32x16_bf16 v[24:39], v[168:171], v[56:59], v[24:39]
    v_mfma_f32_32x32x16_bf16 v[40:55], v[168:171], v[60:63], v[40:55]
    ds_read_b128 v[56:59], v13 offset:32768
    ds_read_b128 v[60:63], v13 offset:34816
    s_waitcnt lgkmcnt(2)
    v_mfma_f32_32x32x16_bf16 v[24:39], v[172:175], v[64:67], v[24:39]
    v_mfma_f32_32x32x16_bf16 v[40:55], v[172:175], v[68:71], v[40:55]
    ds_read_b128 v[64:67], v14 offset:32768
    ds_read_b128 v[68:71], v14 offset:34816
    s_add_u32 m0, s7, 81920
    v_add_u32_dpp v6, v76, v2 quad_perm:[1,1,1,1] row_mask:0xf bank_mask:0xf
    buffer_load_dwordx4 v6, s[12:15], 0 offen lds
    s_waitcnt lgkmcnt(2)
    v_mfma_f32_32x32x16_bf16 v[24:39], v[176:179], v[56:59], v[24:39]
    v_mfma_f32_32x32x16_bf16 v[40:55], v[176:179], v[60:63], v[40:55]
    ds_read_b128 v[56:59], v13 offset:36864
    ds_read_b128 v[60:63], v13 offset:38912
    s_waitcnt lgkmcnt(2)
    v_mfma_f32_32x32x16_bf16 v[24:39], v[180:183], v[64:67], v[24:39]
    v_mfma_f32_32x32x16_bf16 v[40:55], v[180:183], v[68:71], v[40:55]
    ds_read_b128 v[64:67], v14 offset:36864
    ds_read_b128 v[68:71], v14 offset:38912
    s_add_u32 m0, s7, 86016
    v_add_u32_dpp v7, v77, v2 quad_perm:[1,1,1,1] row_mask:0xf bank_mask:0xf
    buffer_load_dwordx4 v7, s[12:15], 0 offen lds
    s_waitcnt lgkmcnt(2)
    v_mfma_f32_32x32x16_bf16 v[24:39], v[184:187], v[56:59], v[24:39]
    v_mfma_f32_32x32x16_bf16 v[40:55], v[184:187], v[60:63], v[40:55]
    s_waitcnt vmcnt(7)
    s_barrier
    buffer_load_dwordx4 v[88:91], v3, s[8:11], s5 offen offset:0 nt
    buffer_load_dwordx4 v[92:95], v3, s[8:11], s5 offen offset:64 nt
    buffer_load_dwordx4 v[96:99], v3, s[8:11], s5 offen offset:128 nt
    buffer_load_dwordx2 v[100:101], v3, s[8:11], s5 offen offset:192 nt
    ds_read_b128 v[56:59], v9 offset:40960
    ds_read_b128 v[60:63], v9 offset:43008
    s_waitcnt lgkmcnt(2)
    v_mfma_f32_32x32x16_bf16 v[24:39], v[188:191], v[64:67], v[24:39]
    v_mfma_f32_32x32x16_bf16 v[40:55], v[188:191], v[68:71], v[40:55]
    ds_read_b128 v[64:67], v10 offset:40960
    ds_read_b128 v[68:71], v10 offset:43008
    s_add_u32 m0, s7, 90112
    v_add_u32_dpp v6, v78, v2 quad_perm:[1,1,1,1] row_mask:0xf bank_mask:0xf
    buffer_load_dwordx4 v6, s[12:15], 0 offen lds
    s_waitcnt lgkmcnt(2)
    v_mfma_f32_32x32x16_bf16 v[24:39], v[192:195], v[56:59], v[24:39]
    v_mfma_f32_32x32x16_bf16 v[40:55], v[192:195], v[60:63], v[40:55]
    ds_read_b128 v[56:59], v9 offset:45056
    ds_read_b128 v[60:63], v9 offset:47104
    s_waitcnt lgkmcnt(2)
    v_mfma_f32_32x32x16_bf16 v[24:39], v[196:199], v[64:67], v[24:39]
    v_mfma_f32_32x32x16_bf16 v[40:55], v[196:199], v[68:71], v[40:55]
    ds_read_b128 v[64:67], v10 offset:45056
    ds_read_b128 v[68:71], v10 offset:47104
    s_add_u32 m0, s7, 94208
    v_add_u32_dpp v7, v79, v2 quad_perm:[1,1,1,1] row_mask:0xf bank_mask:0xf
    buffer_load_dwordx4 v7, s[12:15], 0 offen lds
    s_waitcnt lgkmcnt(2)
    v_mfma_f32_32x32x16_bf16 v[24:39], v[200:203], v[56:59], v[24:39]
    v_mfma_f32_32x32x16_bf16 v[40:55], v[200:203], v[60:63], v[40:55]
    ds_read_b128 v[56:59], v9 offset:49152
    ds_read_b128 v[60:63], v9 offset:51200
    s_waitcnt lgkmcnt(2)
    v_mfma_f32_32x32x16_bf16 v[24:39], v[204:207], v[64:67], v[24:39]
    v_mfma_f32_32x32x16_bf16 v[40:55], v[204:207], v[68:71], v[40:55]
    ds_read_b128 v[64:67], v10 offset:49152
    ds_read_b128 v[68:71], v10 offset:51200
    s_add_u32 m0, s7, 98304
    v_add_u32_dpp v6, v76, v2 quad_perm:[2,2,2,2] row_mask:0xf bank_mask:0xf
    buffer_load_dwordx4 v6, s[12:15], 0 offen lds
    s_waitcnt lgkmcnt(2)
    v_mfma_f32_32x32x16_bf16 v[24:39], v[208:211], v[56:59], v[24:39]
    v_mfma_f32_32x32x16_bf16 v[40:55], v[208:211], v[60:63], v[40:55]
    ds_read_b128 v[56:59], v9 offset:53248
    ds_read_b128 v[60:63], v9 offset:55296
    s_waitcnt lgkmcnt(2)
    v_mfma_f32_32x32x16_bf16 v[24:39], v[212:215], v[64:67], v[24:39]
    v_mfma_f32_32x32x16_bf16 v[40:55], v[212:215], v[68:71], v[40:55]
    ds_read_b128 v[64:67], v10 offset:53248
    ds_read_b128 v[68:71], v10 offset:55296
    s_add_u32 m0, s7, 102400
    v_add_u32_dpp v7, v77, v2 quad_perm:[2,2,2,2] row_mask:0xf bank_mask:0xf
    buffer_load_dwordx4 v7, s[12:15], 0 offen lds
    s_waitcnt lgkmcnt(2)
    v_mfma_f32_32x32x16_bf16 v[24:39], v[216:219], v[56:59], v[24:39]
    v_mfma_f32_32x32x16_bf16 v[40:55], v[216:219], v[60:63], v[40:55]
    ds_read_b128 v[56:59], v9 offset:57344
    ds_read_b128 v[60:63], v9 offset:59392
    s_waitcnt lgkmcnt(2)
    v_mfma_f32_32x32x16_bf16 v[24:39], v[220:223], v[64:67], v[24:39]
    v_mfma_f32_32x32x16_bf16 v[40:55], v[220:223], v[68:71], v[40:55]
    ds_read_b128 v[64:67], v10 offset:57344
    ds_read_b128 v[68:71], v10 offset:59392
    s_add_u32 m0, s7, 106496
    v_add_u32_dpp v6, v78, v2 quad_perm:[2,2,2,2] row_mask:0xf bank_mask:0xf
    buffer_load_dwordx4 v6, s[12:15], 0 offen lds
    s_waitcnt lgkmcnt(2)
    v_mfma_f32_32x32x16_bf16 v[24:39], v[224:227], v[56:59], v[24:39]
    v_mfma_f32_32x32x16_bf16 v[40:55], v[224:227], v[60:63], v[40:55]
    s_waitcnt vmcnt(11)
    s_barrier
    ds_read_b128 v[56:59], v11 offset:0
    ds_read_b128 v[60:63], v11 offset:2048
    s_waitcnt lgkmcnt(2)
    v_mfma_f32_32x32x16_bf16 v[24:39], v[228:231], v[64:67], v[24:39]
    v_mfma_f32_32x32x16_bf16 v[40:55], v[228:231], v[68:71], v[40:55]
    ds_read_b128 v[64:67], v12 offset:0
    ds_read_b128 v[68:71], v12 offset:2048
    s_add_u32 m0, s7, 110592
    v_add_u32_dpp v7, v79, v2 quad_perm:[2,2,2,2] row_mask:0xf bank_mask:0xf
    buffer_load_dwordx4 v7, s[12:15], 0 offen lds
    s_waitcnt lgkmcnt(2)
    v_mfma_f32_32x32x16_bf16 v[24:39], v[232:235], v[56:59], v[24:39]
    v_mfma_f32_32x32x16_bf16 v[40:55], v[232:235], v[60:63], v[40:55]
    ds_read_b128 v[56:59], v11 offset:4096
    ds_read_b128 v[60:63], v11 offset:6144
    s_waitcnt lgkmcnt(2)
    v_mfma_f32_32x32x16_bf16 v[24:39], v[236:239], v[64:67], v[24:39]
    v_mfma_f32_32x32x16_bf16 v[40:55], v[236:239], v[68:71], v[40:55]
    ds_read_b128 v[64:67], v12 offset:4096
    ds_read_b128 v[68:71], v12 offset:6144
    s_add_u32 m0, s7, 114688
    v_add_u32_dpp v6, v76, v2 quad_perm:[3,3,3,3] row_mask:0xf bank_mask:0xf
    buffer_load_dwordx4 v6, s[12:15], 0 offen lds
    s_waitcnt lgkmcnt(2)
    v_mfma_f32_32x32x16_bf16 v[24:39], v[240:243], v[56:59], v[24:39]
    v_mfma_f32_32x32x16_bf16 v[40:55], v[240:243], v[60:63], v[40:55]
    ds_read_b128 v[56:59], v11 offset:8192
    ds_read_b128 v[60:63], v11 offset:10240
    s_waitcnt lgkmcnt(2)
    v_mfma_f32_32x32x16_bf16 v[24:39], v[244:247], v[64:67], v[24:39]
    v_mfma_f32_32x32x16_bf16 v[40:55], v[244:247], v[68:71], v[40:55]
    ds_read_b128 v[64:67], v12 offset:8192
    ds_read_b128 v[68:71], v12 offset:10240
    s_add_u32 m0, s7, 118784
    v_add_u32_dpp v7, v77, v2 quad_perm:[3,3,3,3] row_mask:0xf bank_mask:0xf
    buffer_load_dwordx4 v7, s[12:15], 0 offen lds
    s_waitcnt lgkmcnt(2)
    v_mfma_f32_32x32x16_bf16 v[24:39], v[248:251], v[56:59], v[24:39]
    v_mfma_f32_32x32x16_bf16 v[40:55], v[248:251], v[60:63], v[40:55]
    ds_read_b128 v[56:59], v11 offset:12288
    ds_read_b128 v[60:63], v11 offset:14336
    s_waitcnt lgkmcnt(2)
    v_mfma_f32_32x32x16_bf16 v[24:39], v[252:255], v[64:67], v[24:39]
    v_mfma_f32_32x32x16_bf16 v[40:55], v[252:255], v[68:71], v[40:55]
    ds_read_b128 v[64:67], v12 offset:12288
    ds_read_b128 v[68:71], v12 offset:14336
    s_add_u32 m0, s7, 0
    v_add_u32_dpp v6, v78, v2 quad_perm:[3,3,3,3] row_mask:0xf bank_mask:0xf
    buffer_load_dwordx4 v6, s[12:15], 0 offen lds
    s_waitcnt lgkmcnt(2)
    v_mfma_f32_32x32x16_bf16 v[24:39], a[0:3], v[56:59], v[24:39]
    v_mfma_f32_32x32x16_bf16 v[40:55], a[0:3], v[60:63], v[40:55]
    ds_read_b128 v[56:59], v11 offset:16384
    ds_read_b128 v[60:63], v11 offset:18432
    s_waitcnt lgkmcnt(2)
    v_mfma_f32_32x32x16_bf16 v[24:39], a[4:7], v[64:67], v[24:39]
    v_mfma_f32_32x32x16_bf16 v[40:55], a[4:7], v[68:71], v[40:55]
    ds_read_b128 v[64:67], v12 offset:16384
    ds_read_b128 v[68:71], v12 offset:18432
    s_add_u32 m0, s7, 4096
    v_add_u32_dpp v7, v79, v2 quad_perm:[3,3,3,3] row_mask:0xf bank_mask:0xf
    buffer_load_dwordx4 v7, s[12:15], 0 offen lds
    s_waitcnt lgkmcnt(2)
    v_mfma_f32_32x32x16_bf16 v[24:39], a[8:11], v[56:59], v[24:39]
    v_mfma_f32_32x32x16_bf16 v[40:55], a[8:11], v[60:63], v[40:55]
    s_waitcnt vmcnt(7)
    s_barrier
    ds_read_b128 v[56:59], v11 offset:20480
    ds_read_b128 v[60:63], v11 offset:22528
    s_waitcnt lgkmcnt(2)
    v_mfma_f32_32x32x16_bf16 v[24:39], a[12:15], v[64:67], v[24:39]
    v_mfma_f32_32x32x16_bf16 v[40:55], a[12:15], v[68:71], v[40:55]
    ds_read_b128 v[64:67], v12 offset:20480
    ds_read_b128 v[68:71], v12 offset:22528
    s_add_u32 m0, s7, 8192
    v_add_u32_dpp v6, v80, v2 quad_perm:[0,0,0,0] row_mask:0xf bank_mask:0xf
    buffer_load_dwordx4 v6, s[12:15], 0 offen lds
    s_waitcnt lgkmcnt(2)
    v_mfma_f32_32x32x16_bf16 v[24:39], a[16:19], v[56:59], v[24:39]
    v_mfma_f32_32x32x16_bf16 v[40:55], a[16:19], v[60:63], v[40:55]
    ds_read_b128 v[56:59], v11 offset:24576
    ds_read_b128 v[60:63], v11 offset:26624
    s_waitcnt lgkmcnt(2)
    v_mfma_f32_32x32x16_bf16 v[24:39], a[20:23], v[64:67], v[24:39]
    v_mfma_f32_32x32x16_bf16 v[40:55], a[20:23], v[68:71], v[40:55]
    ds_read_b128 v[64:67], v12 offset:24576
    ds_read_b128 v[68:71], v12 offset:26624
    s_add_u32 m0, s7, 12288
    v_add_u32_dpp v7, v81, v2 quad_perm:[0,0,0,0] row_mask:0xf bank_mask:0xf
    buffer_load_dwordx4 v7, s[12:15], 0 offen lds
    s_waitcnt lgkmcnt(2)
    v_mfma_f32_32x32x16_bf16 v[24:39], a[24:27], v[56:59], v[24:39]
    v_mfma_f32_32x32x16_bf16 v[40:55], a[24:27], v[60:63], v[40:55]
    ds_read_b128 v[56:59], v11 offset:28672
    ds_read_b128 v[60:63], v11 offset:30720
    s_waitcnt lgkmcnt(2)
    v_mfma_f32_32x32x16_bf16 v[24:39], a[28:31], v[64:67], v[24:39]
    v_mfma_f32_32x32x16_bf16 v[40:55], a[28:31], v[68:71], v[40:55]
    ds_read_b128 v[64:67], v12 offset:28672
    ds_read_b128 v[68:71], v12 offset:30720
    s_add_u32 m0, s7, 16384
    v_add_u32_dpp v6, v82, v2 quad_perm:[0,0,0,0] row_mask:0xf bank_mask:0xf
    buffer_load_dwordx4 v6, s[12:15], 0 offen lds
    s_waitcnt lgkmcnt(2)
    v_mfma_f32_32x32x16_bf16 v[24:39], a[32:35], v[56:59], v[24:39]
    v_mfma_f32_32x32x16_bf16 v[40:55], a[32:35], v[60:63], v[40:55]
    ds_read_b128 v[56:59], v11 offset:32768
    ds_read_b128 v[60:63], v11 offset:34816
    s_waitcnt lgkmcnt(2)
    v_mfma_f32_32x32x16_bf16 v[24:39], a[36:39], v[64:67], v[24:39]
    v_mfma_f32_32x32x16_bf16 v[40:55], a[36:39], v[68:71], v[40:55]
    ds_read_b128 v[64:67], v12 offset:32768
    ds_read_b128 v[68:71], v12 offset:34816
    s_add_u32 m0, s7, 20480
    v_add_u32_dpp v7, v83, v2 quad_perm:[0,0,0,0] row_mask:0xf bank_mask:0xf
    buffer_load_dwordx4 v7, s[12:15], 0 offen lds
    s_waitcnt lgkmcnt(2)
    v_mfma_f32_32x32x16_bf16 v[24:39], a[40:43], v[56:59], v[24:39]
    v_mfma_f32_32x32x16_bf16 v[40:55], a[40:43], v[60:63], v[40:55]
    ds_read_b128 v[56:59], v11 offset:36864
    ds_read_b128 v[60:63], v11 offset:38912
    s_waitcnt lgkmcnt(2)
    v_mfma_f32_32x32x16_bf16 v[24:39], a[44:47], v[64:67], v[24:39]
    v_mfma_f32_32x32x16_bf16 v[40:55], a[44:47], v[68:71], v[40:55]
    ds_read_b128 v[64:67], v12 offset:36864
    ds_read_b128 v[68:71], v12 offset:38912
    s_add_u32 m0, s7, 24576
    v_add_u32_dpp v6, v80, v2 quad_perm:[1,1,1,1] row_mask:0xf bank_mask:0xf
    buffer_load_dwordx4 v6, s[12:15], 0 offen lds
    s_waitcnt lgkmcnt(2)
    v_mfma_f32_32x32x16_bf16 v[24:39], a[48:51], v[56:59], v[24:39]
    v_mfma_f32_32x32x16_bf16 v[40:55], a[48:51], v[60:63], v[40:55]
    s_waitcnt vmcnt(7)
    s_barrier
    ds_read_b128 v[56:59], v11 offset:40960
    ds_read_b128 v[60:63], v11 offset:43008
    s_waitcnt lgkmcnt(2)
    v_mfma_f32_32x32x16_bf16 v[24:39], a[52:55], v[64:67], v[24:39]
    v_mfma_f32_32x32x16_bf16 v[40:55], a[52:55], v[68:71], v[40:55]
    ds_read_b128 v[64:67], v12 offset:40960
    ds_read_b128 v[68:71], v12 offset:43008
    s_add_u32 m0, s7, 28672
    v_add_u32_dpp v7, v81, v2 quad_perm:[1,1,1,1] row_mask:0xf bank_mask:0xf
    buffer_load_dwordx4 v7, s[12:15], 0 offen lds
    s_waitcnt lgkmcnt(2)
    v_mfma_f32_32x32x16_bf16 v[24:39], a[56:59], v[56:59], v[24:39]
    v_mfma_f32_32x32x16_bf16 v[40:55], a[56:59], v[60:63], v[40:55]
    ds_read_b128 v[56:59], v11 offset:45056
    ds_read_b128 v[60:63], v11 offset:47104
    s_waitcnt lgkmcnt(2)
    v_mfma_f32_32x32x16_bf16 v[24:39], a[60:63], v[64:67], v[24:39]
    v_mfma_f32_32x32x16_bf16 v[40:55], a[60:63], v[68:71], v[40:55]
    ds_read_b128 v[64:67], v12 offset:45056
    ds_read_b128 v[68:71], v12 offset:47104
    s_add_u32 m0, s7, 32768
    v_add_u32_dpp v6, v82, v2 quad_perm:[1,1,1,1] row_mask:0xf bank_mask:0xf
    buffer_load_dwordx4 v6, s[12:15], 0 offen lds
    s_waitcnt lgkmcnt(2)
    v_mfma_f32_32x32x16_bf16 v[24:39], a[64:67], v[56:59], v[24:39]
    v_mfma_f32_32x32x16_bf16 v[40:55], a[64:67], v[60:63], v[40:55]
    ds_read_b128 v[56:59], v11 offset:49152
    ds_read_b128 v[60:63], v11 offset:51200
    s_waitcnt lgkmcnt(2)
    v_mfma_f32_32x32x16_bf16 v[24:39], a[68:71], v[64:67], v[24:39]
    v_mfma_f32_32x32x16_bf16 v[40:55], a[68:71], v[68:71], v[40:55]
    ds_read_b128 v[64:67], v12 offset:49152
    ds_read_b128 v[68:71], v12 offset:51200
    s_add_u32 m0, s7, 36864
    v_add_u32_dpp v7, v83, v2 quad_perm:[1,1,1,1] row_mask:0xf bank_mask:0xf
    buffer_load_dwordx4 v7, s[12:15], 0 offen lds
    s_waitcnt lgkmcnt(2)
    v_mfma_f32_32x32x16_bf16 v[24:39], a[72:75], v[56:59], v[24:39]
    v_mfma_f32_32x32x16_bf16 v[40:55], a[72:75], v[60:63], v[40:55]
    ds_read_b128 v[56:59], v11 offset:53248
    ds_read_b128 v[60:63], v11 offset:55296
    s_waitcnt lgkmcnt(2)
    v_mfma_f32_32x32x16_bf16 v[24:39], a[76:79], v[64:67], v[24:39]
    v_mfma_f32_32x32x16_bf16 v[40:55], a[76:79], v[68:71], v[40:55]
    ds_read_b128 v[64:67], v12 offset:53248
    ds_read_b128 v[68:71], v12 offset:55296
    s_add_u32 m0, s7, 122880
    v_add_u32_dpp v6, v80, v2 quad_perm:[2,2,2,2] row_mask:0xf bank_mask:0xf
    buffer_load_dwordx4 v6, s[12:15], 0 offen lds
    s_waitcnt lgkmcnt(2)
    v_mfma_f32_32x32x16_bf16 v[24:39], a[80:83], v[56:59], v[24:39]
    v_mfma_f32_32x32x16_bf16 v[40:55], a[80:83], v[60:63], v[40:55]
    ds_read_b128 v[56:59], v11 offset:57344
    ds_read_b128 v[60:63], v11 offset:59392
    s_waitcnt lgkmcnt(2)
    v_mfma_f32_32x32x16_bf16 v[24:39], a[84:87], v[64:67], v[24:39]
    v_mfma_f32_32x32x16_bf16 v[40:55], a[84:87], v[68:71], v[40:55]
    ds_read_b128 v[64:67], v12 offset:57344
    ds_read_b128 v[68:71], v12 offset:59392
    s_add_u32 m0, s7, 126976
    v_add_u32_dpp v7, v81, v2 quad_perm:[2,2,2,2] row_mask:0xf bank_mask:0xf
    buffer_load_dwordx4 v7, s[12:15], 0 offen lds
    s_waitcnt lgkmcnt(2)
    v_mfma_f32_32x32x16_bf16 v[24:39], a[88:91], v[56:59], v[24:39]
    v_mfma_f32_32x32x16_bf16 v[40:55], a[88:91], v[60:63], v[40:55]
    s_waitcnt vmcnt(7)
    s_barrier
    ds_read_b128 v[56:59], v9 offset:0
    ds_read_b128 v[60:63], v9 offset:2048
    s_waitcnt lgkmcnt(2)
    v_mfma_f32_32x32x16_bf16 v[24:39], a[92:95], v[64:67], v[24:39]
    v_mfma_f32_32x32x16_bf16 v[40:55], a[92:95], v[68:71], v[40:55]
    ds_read_b128 v[64:67], v10 offset:0
    ds_read_b128 v[68:71], v10 offset:2048
    s_add_u32 m0, s7, 131072
    v_add_u32_dpp v6, v82, v2 quad_perm:[2,2,2,2] row_mask:0xf bank_mask:0xf
    buffer_load_dwordx4 v6, s[12:15], 0 offen lds
    s_waitcnt lgkmcnt(2)
    v_mfma_f32_32x32x16_bf16 v[24:39], a[96:99], v[56:59], v[24:39]
    v_mfma_f32_32x32x16_bf16 v[40:55], a[96:99], v[60:63], v[40:55]
    ds_read_b128 v[56:59], v9 offset:4096
    ds_read_b128 v[60:63], v9 offset:6144
    s_waitcnt lgkmcnt(2)
    v_mfma_f32_32x32x16_bf16 v[24:39], a[100:103], v[64:67], v[24:39]
    v_mfma_f32_32x32x16_bf16 v[40:55], a[100:103], v[68:71], v[40:55]
    ds_read_b128 v[64:67], v10 offset:4096
    ds_read_b128 v[68:71], v10 offset:6144
    s_add_u32 m0, s7, 135168
    v_add_u32_dpp v7, v83, v2 quad_perm:[2,2,2,2] row_mask:0xf bank_mask:0xf
    buffer_load_dwordx4 v7, s[12:15], 0 offen lds
    s_waitcnt lgkmcnt(2)
    v_mfma_f32_32x32x16_bf16 v[24:39], a[104:107], v[56:59], v[24:39]
    v_mfma_f32_32x32x16_bf16 v[40:55], a[104:107], v[60:63], v[40:55]
    ds_read_b128 v[56:59], v9 offset:8192
    ds_read_b128 v[60:63], v9 offset:10240
    s_waitcnt lgkmcnt(2)
    v_mfma_f32_32x32x16_bf16 v[24:39], a[108:111], v[64:67], v[24:39]
    v_mfma_f32_32x32x16_bf16 v[40:55], a[108:111], v[68:71], v[40:55]
    ds_read_b128 v[64:67], v10 offset:8192
    ds_read_b128 v[68:71], v10 offset:10240
    s_add_u32 m0, s7, 139264
    v_add_u32_dpp v6, v80, v2 quad_perm:[3,3,3,3] row_mask:0xf bank_mask:0xf
    buffer_load_dwordx4 v6, s[12:15], 0 offen lds
    s_waitcnt lgkmcnt(2)
    v_mfma_f32_32x32x16_bf16 v[24:39], a[112:115], v[56:59], v[24:39]
    v_mfma_f32_32x32x16_bf16 v[40:55], a[112:115], v[60:63], v[40:55]
    ds_read_b128 v[56:59], v9 offset:12288
    ds_read_b128 v[60:63], v9 offset:14336
    s_waitcnt lgkmcnt(2)
    v_mfma_f32_32x32x16_bf16 v[24:39], a[116:119], v[64:67], v[24:39]
    v_mfma_f32_32x32x16_bf16 v[40:55], a[116:119], v[68:71], v[40:55]
    ds_read_b128 v[64:67], v10 offset:12288
    ds_read_b128 v[68:71], v10 offset:14336
    s_add_u32 m0, s7, 143360
    v_add_u32_dpp v7, v81, v2 quad_perm:[3,3,3,3] row_mask:0xf bank_mask:0xf
    buffer_load_dwordx4 v7, s[12:15], 0 offen lds
    s_waitcnt lgkmcnt(2)
    v_mfma_f32_32x32x16_bf16 v[24:39], a[120:123], v[56:59], v[24:39]
    v_mfma_f32_32x32x16_bf16 v[40:55], a[120:123], v[60:63], v[40:55]
    ds_read_b128 v[56:59], v9 offset:16384
    ds_read_b128 v[60:63], v9 offset:18432
    s_waitcnt lgkmcnt(2)
    v_mfma_f32_32x32x16_bf16 v[24:39], a[124:127], v[64:67], v[24:39]
    v_mfma_f32_32x32x16_bf16 v[40:55], a[124:127], v[68:71], v[40:55]
    ds_read_b128 v[64:67], v10 offset:16384
    ds_read_b128 v[68:71], v10 offset:18432
    s_add_u32 m0, s7, 147456
    v_add_u32_dpp v6, v82, v2 quad_perm:[3,3,3,3] row_mask:0xf bank_mask:0xf
    buffer_load_dwordx4 v6, s[12:15], 0 offen lds
    s_waitcnt lgkmcnt(2)
    v_mfma_f32_32x32x16_bf16 v[24:39], a[128:131], v[56:59], v[24:39]
    v_mfma_f32_32x32x16_bf16 v[40:55], a[128:131], v[60:63], v[40:55]
    s_waitcnt vmcnt(7)
    s_barrier
    ds_read_b128 v[56:59], v9 offset:20480
    ds_read_b128 v[60:63], v9 offset:22528
    s_waitcnt lgkmcnt(2)
    v_mfma_f32_32x32x16_bf16 v[24:39], a[132:135], v[64:67], v[24:39]
    v_mfma_f32_32x32x16_bf16 v[40:55], a[132:135], v[68:71], v[40:55]
    ds_read_b128 v[64:67], v10 offset:20480
    ds_read_b128 v[68:71], v10 offset:22528
    s_add_u32 m0, s7, 151552
    v_add_u32_dpp v7, v83, v2 quad_perm:[3,3,3,3] row_mask:0xf bank_mask:0xf
    buffer_load_dwordx4 v7, s[12:15], 0 offen lds
    s_waitcnt lgkmcnt(2)
    v_mfma_f32_32x32x16_bf16 v[24:39], a[136:139], v[56:59], v[24:39]
    v_mfma_f32_32x32x16_bf16 v[40:55], a[136:139], v[60:63], v[40:55]
    ds_read_b128 v[56:59], v9 offset:24576
    ds_read_b128 v[60:63], v9 offset:26624
    s_waitcnt lgkmcnt(2)
    v_mfma_f32_32x32x16_bf16 v[24:39], a[140:143], v[64:67], v[24:39]
    v_mfma_f32_32x32x16_bf16 v[40:55], a[140:143], v[68:71], v[40:55]
    ds_read_b128 v[64:67], v10 offset:24576
    ds_read_b128 v[68:71], v10 offset:26624
    s_add_u32 m0, s7, 155648
    v_add_u32_dpp v6, v84, v2 quad_perm:[0,0,0,0] row_mask:0xf bank_mask:0xf
    buffer_load_dwordx4 v6, s[12:15], 0 offen lds
    s_waitcnt lgkmcnt(2)
    v_mfma_f32_32x32x16_bf16 v[24:39], a[144:147], v[56:59], v[24:39]
    v_mfma_f32_32x32x16_bf16 v[40:55], a[144:147], v[60:63], v[40:55]
    ds_read_b128 v[56:59], v9 offset:28672
    ds_read_b128 v[60:63], v9 offset:30720
    s_waitcnt lgkmcnt(2)
    v_mfma_f32_32x32x16_bf16 v[24:39], a[148:151], v[64:67], v[24:39]
    v_mfma_f32_32x32x16_bf16 v[40:55], a[148:151], v[68:71], v[40:55]
    ds_read_b128 v[64:67], v10 offset:28672
    ds_read_b128 v[68:71], v10 offset:30720
    s_add_u32 m0, s7, 159744
    v_add_u32_dpp v7, v85, v2 quad_perm:[0,0,0,0] row_mask:0xf bank_mask:0xf
    buffer_load_dwordx4 v7, s[12:15], 0 offen lds
    s_waitcnt lgkmcnt(2)
    v_mfma_f32_32x32x16_bf16 v[24:39], a[152:155], v[56:59], v[24:39]
    v_mfma_f32_32x32x16_bf16 v[40:55], a[152:155], v[60:63], v[40:55]
    ds_read_b128 v[56:59], v9 offset:32768
    ds_read_b128 v[60:63], v9 offset:34816
    s_waitcnt lgkmcnt(2)
    v_mfma_f32_32x32x16_bf16 v[24:39], a[156:159], v[64:67], v[24:39]
    v_mfma_f32_32x32x16_bf16 v[40:55], a[156:159], v[68:71], v[40:55]
    ds_read_b128 v[64:67], v10 offset:32768
    ds_read_b128 v[68:71], v10 offset:34816
    v_lshlrev_b32 v88, 6, v88
    v_lshlrev_b32 v89, 6, v89
    v_lshlrev_b32 v90, 6, v90
    v_lshlrev_b32 v91, 6, v91
    v_lshlrev_b32 v92, 6, v92
    v_lshlrev_b32 v93, 6, v93
    v_lshlrev_b32 v94, 6, v94
    v_lshlrev_b32 v95, 6, v95
    v_lshlrev_b32 v96, 6, v96
    v_lshlrev_b32 v97, 6, v97
    v_lshlrev_b32 v98, 6, v98
    v_lshlrev_b32 v99, 6, v99
    v_lshlrev_b32 v100, 6, v100
    v_lshlrev_b32 v101, 6, v101
    s_nop 1
    s_add_u32 m0, s7, 40960
    v_add_u32_dpp v6, v88, v2 quad_perm:[0,0,0,0] row_mask:0xf bank_mask:0xf
    buffer_load_dwordx4 v6, s[12:15], 0 offen lds
    s_waitcnt lgkmcnt(2)
    v_mfma_f32_32x32x16_bf16 v[24:39], a[160:163], v[56:59], v[24:39]
    v_mfma_f32_32x32x16_bf16 v[40:55], a[160:163], v[60:63], v[40:55]
    ds_read_b128 v[56:59], v9 offset:36864
    ds_read_b128 v[60:63], v9 offset:38912
    s_waitcnt lgkmcnt(2)
    v_mfma_f32_32x32x16_bf16 v[24:39], a[164:167], v[64:67], v[24:39]
    v_mfma_f32_32x32x16_bf16 v[40:55], a[164:167], v[68:71], v[40:55]
    ds_read_b128 v[64:67], v10 offset:36864
    ds_read_b128 v[68:71], v10 offset:38912
    s_add_u32 m0, s7, 45056
    v_add_u32_dpp v7, v89, v2 quad_perm:[0,0,0,0] row_mask:0xf bank_mask:0xf
    buffer_load_dwordx4 v7, s[12:15], 0 offen lds
    s_waitcnt lgkmcnt(2)
    v_mfma_f32_32x32x16_bf16 v[24:39], a[168:171], v[56:59], v[24:39]
    v_mfma_f32_32x32x16_bf16 v[40:55], a[168:171], v[60:63], v[40:55]
    s_waitcnt vmcnt(7)
    s_barrier
    ds_read_b128 v[56:59], v13 offset:0
    ds_read_b128 v[60:63], v13 offset:2048
    s_waitcnt lgkmcnt(2)
    v_mfma_f32_32x32x16_bf16 v[24:39], a[172:175], v[64:67], v[24:39]
    v_mfma_f32_32x32x16_bf16 v[40:55], a[172:175], v[68:71], v[40:55]
    ds_read_b128 v[64:67], v14 offset:0
    ds_read_b128 v[68:71], v14 offset:2048
    s_add_u32 m0, s7, 49152
    v_add_u32_dpp v6, v90, v2 quad_perm:[0,0,0,0] row_mask:0xf bank_mask:0xf
    buffer_load_dwordx4 v6, s[12:15], 0 offen lds
    s_waitcnt lgkmcnt(2)
    v_mfma_f32_32x32x16_bf16 v[24:39], a[176:179], v[56:59], v[24:39]
    v_mfma_f32_32x32x16_bf16 v[40:55], a[176:179], v[60:63], v[40:55]
    ds_read_b128 v[56:59], v13 offset:4096
    ds_read_b128 v[60:63], v13 offset:6144
    s_waitcnt lgkmcnt(2)
    v_mfma_f32_32x32x16_bf16 v[24:39], a[180:183], v[64:67], v[24:39]
    v_mfma_f32_32x32x16_bf16 v[40:55], a[180:183], v[68:71], v[40:55]
    ds_read_b128 v[64:67], v14 offset:4096
    ds_read_b128 v[68:71], v14 offset:6144
    s_add_u32 m0, s7, 53248
    v_add_u32_dpp v7, v91, v2 quad_perm:[0,0,0,0] row_mask:0xf bank_mask:0xf
    buffer_load_dwordx4 v7, s[12:15], 0 offen lds
    s_waitcnt lgkmcnt(2)
    v_mfma_f32_32x32x16_bf16 v[24:39], a[184:187], v[56:59], v[24:39]
    v_mfma_f32_32x32x16_bf16 v[40:55], a[184:187], v[60:63], v[40:55]
    ds_read_b128 v[56:59], v13 offset:8192
    ds_read_b128 v[60:63], v13 offset:10240
    s_waitcnt lgkmcnt(2)
    v_mfma_f32_32x32x16_bf16 v[24:39], a[188:191], v[64:67], v[24:39]
    v_mfma_f32_32x32x16_bf16 v[40:55], a[188:191], v[68:71], v[40:55]
    ds_read_b128 v[64:67], v14 offset:8192
    ds_read_b128 v[68:71], v14 offset:10240
    s_add_u32 m0, s7, 57344
    v_add_u32_dpp v6, v88, v2 quad_perm:[1,1,1,1] row_mask:0xf bank_mask:0xf
    buffer_load_dwordx4 v6, s[12:15], 0 offen lds
    s_waitcnt lgkmcnt(2)
    v_mfma_f32_32x32x16_bf16 v[24:39], a[192:195], v[56:59], v[24:39]
    v_mfma_f32_32x32x16_bf16 v[40:55], a[192:195], v[60:63], v[40:55]
    ds_read_b128 v[56:59], v13 offset:12288
    ds_read_b128 v[60:63], v13 offset:14336
    s_waitcnt lgkmcnt(2)
    v_mfma_f32_32x32x16_bf16 v[24:39], a[196:199], v[64:67], v[24:39]
    v_mfma_f32_32x32x16_bf16 v[40:55], a[196:199], v[68:71], v[40:55]
    ds_read_b128 v[64:67], v14 offset:12288
    ds_read_b128 v[68:71], v14 offset:14336
    s_add_u32 m0, s7, 61440
    v_add_u32_dpp v7, v89, v2 quad_perm:[1,1,1,1] row_mask:0xf bank_mask:0xf
    buffer_load_dwordx4 v7, s[12:15], 0 offen lds
    s_waitcnt lgkmcnt(2)
    v_mfma_f32_32x32x16_bf16 v[24:39], a[200:203], v[56:59], v[24:39]
    v_mfma_f32_32x32x16_bf16 v[40:55], a[200:203], v[60:63], v[40:55]
    ds_read_b128 v[56:59], v13 offset:16384
    ds_read_b128 v[60:63], v13 offset:18432
    s_waitcnt lgkmcnt(2)
    v_mfma_f32_32x32x16_bf16 v[24:39], a[204:207], v[64:67], v[24:39]
    v_mfma_f32_32x32x16_bf16 v[40:55], a[204:207], v[68:71], v[40:55]
    ds_read_b128 v[64:67], v14 offset:16384
    ds_read_b128 v[68:71], v14 offset:18432
    s_add_u32 m0, s7, 65536
    v_add_u32_dpp v6, v90, v2 quad_perm:[1,1,1,1] row_mask:0xf bank_mask:0xf
    buffer_load_dwordx4 v6, s[12:15], 0 offen lds
    s_waitcnt lgkmcnt(2)
    v_mfma_f32_32x32x16_bf16 v[24:39], a[208:211], v[56:59], v[24:39]
    v_mfma_f32_32x32x16_bf16 v[40:55], a[208:211], v[60:63], v[40:55]
    s_waitcnt vmcnt(7)
    s_barrier
    ds_read_b128 v[56:59], v13 offset:20480
    ds_read_b128 v[60:63], v13 offset:22528
    s_waitcnt lgkmcnt(2)
    v_mfma_f32_32x32x16_bf16 v[24:39], a[212:215], v[64:67], v[24:39]
    v_mfma_f32_32x32x16_bf16 v[40:55], a[212:215], v[68:71], v[40:55]
    ds_read_b128 v[64:67], v14 offset:20480
    ds_read_b128 v[68:71], v14 offset:22528
    s_add_u32 m0, s7, 69632
    v_add_u32_dpp v7, v91, v2 quad_perm:[1,1,1,1] row_mask:0xf bank_mask:0xf
    buffer_load_dwordx4 v7, s[12:15], 0 offen lds
    s_waitcnt lgkmcnt(2)
    v_mfma_f32_32x32x16_bf16 v[24:39], a[216:219], v[56:59], v[24:39]
    v_mfma_f32_32x32x16_bf16 v[40:55], a[216:219], v[60:63], v[40:55]
    ds_read_b128 v[56:59], v13 offset:24576
    ds_read_b128 v[60:63], v13 offset:26624
    s_waitcnt lgkmcnt(2)
    v_mfma_f32_32x32x16_bf16 v[24:39], a[220:223], v[64:67], v[24:39]
    v_mfma_f32_32x32x16_bf16 v[40:55], a[220:223], v[68:71], v[40:55]
    ds_read_b128 v[64:67], v14 offset:24576
    ds_read_b128 v[68:71], v14 offset:26624
    s_add_u32 m0, s7, 73728
    v_add_u32_dpp v6, v88, v2 quad_perm:[2,2,2,2] row_mask:0xf bank_mask:0xf
    buffer_load_dwordx4 v6, s[12:15], 0 offen lds
    s_waitcnt lgkmcnt(2)
    v_mfma_f32_32x32x16_bf16 v[24:39], a[224:227], v[56:59], v[24:39]
    v_mfma_f32_32x32x16_bf16 v[40:55], a[224:227], v[60:63], v[40:55]
    ds_read_b128 v[56:59], v13 offset:28672
    ds_read_b128 v[60:63], v13 offset:30720
    s_waitcnt lgkmcnt(2)
    v_mfma_f32_32x32x16_bf16 v[24:39], a[228:231], v[64:67], v[24:39]
    v_mfma_f32_32x32x16_bf16 v[40:55], a[228:231], v[68:71], v[40:55]
    ds_read_b128 v[64:67], v14 offset:28672
    ds_read_b128 v[68:71], v14 offset:30720
    s_add_u32 m0, s7, 77824
    v_add_u32_dpp v7, v89, v2 quad_perm:[2,2,2,2] row_mask:0xf bank_mask:0xf
    buffer_load_dwordx4 v7, s[12:15], 0 offen lds
    s_waitcnt lgkmcnt(2)
    v_mfma_f32_32x32x16_bf16 v[24:39], a[232:235], v[56:59], v[24:39]
    v_mfma_f32_32x32x16_bf16 v[40:55], a[232:235], v[60:63], v[40:55]
    ds_read_b128 v[56:59], v13 offset:32768
    ds_read_b128 v[60:63], v13 offset:34816
    s_waitcnt lgkmcnt(2)
    v_mfma_f32_32x32x16_bf16 v[24:39], a[236:239], v[64:67], v[24:39]
    v_mfma_f32_32x32x16_bf16 v[40:55], a[236:239], v[68:71], v[40:55]
    ds_read_b128 v[64:67], v14 offset:32768
    ds_read_b128 v[68:71], v14 offset:34816
    s_add_u32 m0, s7, 81920
    v_add_u32_dpp v6, v90, v2 quad_perm:[2,2,2,2] row_mask:0xf bank_mask:0xf
    buffer_load_dwordx4 v6, s[12:15], 0 offen lds
    s_waitcnt lgkmcnt(2)
    v_mfma_f32_32x32x16_bf16 v[24:39], a[240:243], v[56:59], v[24:39]
    v_mfma_f32_32x32x16_bf16 v[40:55], a[240:243], v[60:63], v[40:55]
    ds_read_b128 v[56:59], v13 offset:36864
    ds_read_b128 v[60:63], v13 offset:38912
    s_waitcnt lgkmcnt(2)
    v_mfma_f32_32x32x16_bf16 v[24:39], a[244:247], v[64:67], v[24:39]
    v_mfma_f32_32x32x16_bf16 v[40:55], a[244:247], v[68:71], v[40:55]
    ds_read_b128 v[64:67], v14 offset:36864
    ds_read_b128 v[68:71], v14 offset:38912
    s_add_u32 m0, s7, 86016
    v_add_u32_dpp v7, v91, v2 quad_perm:[2,2,2,2] row_mask:0xf bank_mask:0xf
    buffer_load_dwordx4 v7, s[12:15], 0 offen lds
    s_waitcnt lgkmcnt(2)
    v_mfma_f32_32x32x16_bf16 v[24:39], a[248:251], v[56:59], v[24:39]
    v_mfma_f32_32x32x16_bf16 v[40:55], a[248:251], v[60:63], v[40:55]
    s_waitcnt vmcnt(7)
    s_barrier
    ds_read_b128 v[56:59], v9 offset:40960
    ds_read_b128 v[60:63], v9 offset:43008
    s_waitcnt lgkmcnt(2)
    v_mfma_f32_32x32x16_bf16 v[24:39], a[252:255], v[64:67], v[24:39]
    v_mfma_f32_32x32x16_bf16 v[40:55], a[252:255], v[68:71], v[40:55]
    ds_read_b128 v[64:67], v10 offset:40960
    ds_read_b128 v[68:71], v10 offset:43008
    s_nop 15
    v_cvt_pk_bf16_f32 v72, v24, v25
    v_cvt_pk_bf16_f32 v73, v26, v27
    v_cvt_pk_bf16_f32 v74, v28, v29
    v_cvt_pk_bf16_f32 v75, v30, v31
    v_cvt_pk_bf16_f32 v76, v32, v33
    v_cvt_pk_bf16_f32 v77, v34, v35
    v_cvt_pk_bf16_f32 v78, v36, v37
    v_cvt_pk_bf16_f32 v79, v38, v39
    v_cvt_pk_bf16_f32 v80, v40, v41
    v_cvt_pk_bf16_f32 v81, v42, v43
    v_cvt_pk_bf16_f32 v82, v44, v45
    v_cvt_pk_bf16_f32 v83, v46, v47
    v_cvt_pk_bf16_f32 v84, v48, v49
    v_cvt_pk_bf16_f32 v85, v50, v51
    v_cvt_pk_bf16_f32 v86, v52, v53
    v_cvt_pk_bf16_f32 v87, v54, v55
    buffer_store_dwordx4 v[72:75], v5, s[20:23], s93 offen offset:0 sc1
    s_add_u32 m0, s7, 90112
    v_add_u32_dpp v6, v88, v2 quad_perm:[3,3,3,3] row_mask:0xf bank_mask:0xf
    buffer_load_dwordx4 v6, s[12:15], 0 offen lds
    s_waitcnt lgkmcnt(2)
    v_mfma_f32_32x32x16_bf16 v[24:39], v[112:115], v[56:59], 0
    v_mfma_f32_32x32x16_bf16 v[40:55], v[112:115], v[60:63], 0
    ds_read_b128 v[56:59], v9 offset:45056
    ds_read_b128 v[60:63], v9 offset:47104
    s_waitcnt lgkmcnt(2)
    v_mfma_f32_32x32x16_bf16 v[24:39], v[116:119], v[64:67], v[24:39]
    v_mfma_f32_32x32x16_bf16 v[40:55], v[116:119], v[68:71], v[40:55]
    ds_read_b128 v[64:67], v10 offset:45056
    ds_read_b128 v[68:71], v10 offset:47104
    s_add_u32 m0, s7, 94208
    v_add_u32_dpp v7, v89, v2 quad_perm:[3,3,3,3] row_mask:0xf bank_mask:0xf
    buffer_load_dwordx4 v7, s[12:15], 0 offen lds
    s_waitcnt lgkmcnt(2)
    v_mfma_f32_32x32x16_bf16 v[24:39], v[120:123], v[56:59], v[24:39]
    v_mfma_f32_32x32x16_bf16 v[40:55], v[120:123], v[60:63], v[40:55]
    ds_read_b128 v[56:59], v9 offset:49152
    ds_read_b128 v[60:63], v9 offset:51200
    s_waitcnt lgkmcnt(2)
    v_mfma_f32_32x32x16_bf16 v[24:39], v[124:127], v[64:67], v[24:39]
    v_mfma_f32_32x32x16_bf16 v[40:55], v[124:127], v[68:71], v[40:55]
    ds_read_b128 v[64:67], v10 offset:49152
    ds_read_b128 v[68:71], v10 offset:51200
    s_add_u32 m0, s7, 98304
    v_add_u32_dpp v6, v90, v2 quad_perm:[3,3,3,3] row_mask:0xf bank_mask:0xf
    buffer_load_dwordx4 v6, s[12:15], 0 offen lds
    s_waitcnt lgkmcnt(2)
    v_mfma_f32_32x32x16_bf16 v[24:39], v[128:131], v[56:59], v[24:39]
    v_mfma_f32_32x32x16_bf16 v[40:55], v[128:131], v[60:63], v[40:55]
    ds_read_b128 v[56:59], v9 offset:53248
    ds_read_b128 v[60:63], v9 offset:55296
    s_waitcnt lgkmcnt(2)
    v_mfma_f32_32x32x16_bf16 v[24:39], v[132:135], v[64:67], v[24:39]
    v_mfma_f32_32x32x16_bf16 v[40:55], v[132:135], v[68:71], v[40:55]
    ds_read_b128 v[64:67], v10 offset:53248
    ds_read_b128 v[68:71], v10 offset:55296
    buffer_store_dwordx4 v[76:79], v5, s[20:23], s93 offen offset:1024 sc1
    s_add_u32 m0, s7, 102400
    v_add_u32_dpp v7, v91, v2 quad_perm:[3,3,3,3] row_mask:0xf bank_mask:0xf
    buffer_load_dwordx4 v7, s[12:15], 0 offen lds
    s_waitcnt lgkmcnt(2)
    v_mfma_f32_32x32x16_bf16 v[24:39], v[136:139], v[56:59], v[24:39]
    v_mfma_f32_32x32x16_bf16 v[40:55], v[136:139], v[60:63], v[40:55]
    ds_read_b128 v[56:59], v9 offset:57344
    ds_read_b128 v[60:63], v9 offset:59392
    s_waitcnt lgkmcnt(2)
    v_mfma_f32_32x32x16_bf16 v[24:39], v[140:143], v[64:67], v[24:39]
    v_mfma_f32_32x32x16_bf16 v[40:55], v[140:143], v[68:71], v[40:55]
    ds_read_b128 v[64:67], v10 offset:57344
    ds_read_b128 v[68:71], v10 offset:59392
    s_add_u32 m0, s7, 106496
    v_add_u32_dpp v6, v92, v2 quad_perm:[0,0,0,0] row_mask:0xf bank_mask:0xf
    buffer_load_dwordx4 v6, s[12:15], 0 offen lds
    s_waitcnt lgkmcnt(2)
    v_mfma_f32_32x32x16_bf16 v[24:39], v[144:147], v[56:59], v[24:39]
    v_mfma_f32_32x32x16_bf16 v[40:55], v[144:147], v[60:63], v[40:55]
    s_waitcnt vmcnt(9)
    s_barrier
    ds_read_b128 v[56:59], v11 offset:0
    ds_read_b128 v[60:63], v11 offset:2048
    s_waitcnt lgkmcnt(2)
    v_mfma_f32_32x32x16_bf16 v[24:39], v[148:151], v[64:67], v[24:39]
    v_mfma_f32_32x32x16_bf16 v[40:55], v[148:151], v[68:71], v[40:55]
    ds_read_b128 v[64:67], v12 offset:0
    ds_read_b128 v[68:71], v12 offset:2048
    s_add_u32 m0, s7, 110592
    v_add_u32_dpp v7, v93, v2 quad_perm:[0,0,0,0] row_mask:0xf bank_mask:0xf
    buffer_load_dwordx4 v7, s[12:15], 0 offen lds
    s_waitcnt lgkmcnt(2)
    v_mfma_f32_32x32x16_bf16 v[24:39], v[152:155], v[56:59], v[24:39]
    v_mfma_f32_32x32x16_bf16 v[40:55], v[152:155], v[60:63], v[40:55]
    ds_read_b128 v[56:59], v11 offset:4096
    ds_read_b128 v[60:63], v11 offset:6144
    s_waitcnt lgkmcnt(2)
    v_mfma_f32_32x32x16_bf16 v[24:39], v[156:159], v[64:67], v[24:39]
    v_mfma_f32_32x32x16_bf16 v[40:55], v[156:159], v[68:71], v[40:55]
    ds_read_b128 v[64:67], v12 offset:4096
    ds_read_b128 v[68:71], v12 offset:6144
    buffer_store_dwordx4 v[80:83], v5, s[20:23], s93 offen offset:2048 sc1
    s_add_u32 m0, s7, 114688
    v_add_u32_dpp v6, v94, v2 quad_perm:[0,0,0,0] row_mask:0xf bank_mask:0xf
    buffer_load_dwordx4 v6, s[12:15], 0 offen lds
    s_waitcnt lgkmcnt(2)
    v_mfma_f32_32x32x16_bf16 v[24:39], v[160:163], v[56:59], v[24:39]
    v_mfma_f32_32x32x16_bf16 v[40:55], v[160:163], v[60:63], v[40:55]
    ds_read_b128 v[56:59], v11 offset:8192
    ds_read_b128 v[60:63], v11 offset:10240
    s_waitcnt lgkmcnt(2)
    v_mfma_f32_32x32x16_bf16 v[24:39], v[164:167], v[64:67], v[24:39]
    v_mfma_f32_32x32x16_bf16 v[40:55], v[164:167], v[68:71], v[40:55]
    ds_read_b128 v[64:67], v12 offset:8192
    ds_read_b128 v[68:71], v12 offset:10240
    s_add_u32 m0, s7, 118784
    v_add_u32_dpp v7, v95, v2 quad_perm:[0,0,0,0] row_mask:0xf bank_mask:0xf
    buffer_load_dwordx4 v7, s[12:15], 0 offen lds
    s_waitcnt lgkmcnt(2)
    v_mfma_f32_32x32x16_bf16 v[24:39], v[168:171], v[56:59], v[24:39]
    v_mfma_f32_32x32x16_bf16 v[40:55], v[168:171], v[60:63], v[40:55]
    ds_read_b128 v[56:59], v11 offset:12288
    ds_read_b128 v[60:63], v11 offset:14336
    s_waitcnt lgkmcnt(2)
    v_mfma_f32_32x32x16_bf16 v[24:39], v[172:175], v[64:67], v[24:39]
    v_mfma_f32_32x32x16_bf16 v[40:55], v[172:175], v[68:71], v[40:55]
    ds_read_b128 v[64:67], v12 offset:12288
    ds_read_b128 v[68:71], v12 offset:14336
    s_add_u32 m0, s7, 0
    v_add_u32_dpp v6, v92, v2 quad_perm:[1,1,1,1] row_mask:0xf bank_mask:0xf
    buffer_load_dwordx4 v6, s[12:15], 0 offen lds
    s_waitcnt lgkmcnt(2)
    v_mfma_f32_32x32x16_bf16 v[24:39], v[176:179], v[56:59], v[24:39]
    v_mfma_f32_32x32x16_bf16 v[40:55], v[176:179], v[60:63], v[40:55]
    ds_read_b128 v[56:59], v11 offset:16384
    ds_read_b128 v[60:63], v11 offset:18432
    s_waitcnt lgkmcnt(2)
    v_mfma_f32_32x32x16_bf16 v[24:39], v[180:183], v[64:67], v[24:39]
    v_mfma_f32_32x32x16_bf16 v[40:55], v[180:183], v[68:71], v[40:55]
    ds_read_b128 v[64:67], v12 offset:16384
    ds_read_b128 v[68:71], v12 offset:18432
    buffer_store_dwordx4 v[84:87], v5, s[20:23], s93 offen offset:3072 sc1
    s_add_u32 m0, s7, 4096
    v_add_u32_dpp v7, v93, v2 quad_perm:[1,1,1,1] row_mask:0xf bank_mask:0xf
    buffer_load_dwordx4 v7, s[12:15], 0 offen lds
    s_waitcnt lgkmcnt(2)
    v_mfma_f32_32x32x16_bf16 v[24:39], v[184:187], v[56:59], v[24:39]
    v_mfma_f32_32x32x16_bf16 v[40:55], v[184:187], v[60:63], v[40:55]
    s_waitcnt vmcnt(10)
    s_barrier
    ds_read_b128 v[56:59], v11 offset:20480
    ds_read_b128 v[60:63], v11 offset:22528
    s_waitcnt lgkmcnt(2)
    v_mfma_f32_32x32x16_bf16 v[24:39], v[188:191], v[64:67], v[24:39]
    v_mfma_f32_32x32x16_bf16 v[40:55], v[188:191], v[68:71], v[40:55]
    ds_read_b128 v[64:67], v12 offset:20480
    ds_read_b128 v[68:71], v12 offset:22528
    s_add_u32 m0, s7, 8192
    v_add_u32_dpp v6, v94, v2 quad_perm:[1,1,1,1] row_mask:0xf bank_mask:0xf
    buffer_load_dwordx4 v6, s[12:15], 0 offen lds
    s_waitcnt lgkmcnt(2)
    v_mfma_f32_32x32x16_bf16 v[24:39], v[192:195], v[56:59], v[24:39]
    v_mfma_f32_32x32x16_bf16 v[40:55], v[192:195], v[60:63], v[40:55]
    ds_read_b128 v[56:59], v11 offset:24576
    ds_read_b128 v[60:63], v11 offset:26624
    s_waitcnt lgkmcnt(2)
    v_mfma_f32_32x32x16_bf16 v[24:39], v[196:199], v[64:67], v[24:39]
    v_mfma_f32_32x32x16_bf16 v[40:55], v[196:199], v[68:71], v[40:55]
    ds_read_b128 v[64:67], v12 offset:24576
    ds_read_b128 v[68:71], v12 offset:26624
    s_add_u32 m0, s7, 12288
    v_add_u32_dpp v7, v95, v2 quad_perm:[1,1,1,1] row_mask:0xf bank_mask:0xf
    buffer_load_dwordx4 v7, s[12:15], 0 offen lds
    s_waitcnt lgkmcnt(2)
    v_mfma_f32_32x32x16_bf16 v[24:39], v[200:203], v[56:59], v[24:39]
    v_mfma_f32_32x32x16_bf16 v[40:55], v[200:203], v[60:63], v[40:55]
    ds_read_b128 v[56:59], v11 offset:28672
    ds_read_b128 v[60:63], v11 offset:30720
    s_waitcnt lgkmcnt(2)
    v_mfma_f32_32x32x16_bf16 v[24:39], v[204:207], v[64:67], v[24:39]
    v_mfma_f32_32x32x16_bf16 v[40:55], v[204:207], v[68:71], v[40:55]
    ds_read_b128 v[64:67], v12 offset:28672
    ds_read_b128 v[68:71], v12 offset:30720
    s_add_u32 m0, s7, 16384
    v_add_u32_dpp v6, v92, v2 quad_perm:[2,2,2,2] row_mask:0xf bank_mask:0xf
    buffer_load_dwordx4 v6, s[12:15], 0 offen lds
    s_waitcnt lgkmcnt(2)
    v_mfma_f32_32x32x16_bf16 v[24:39], v[208:211], v[56:59], v[24:39]
    v_mfma_f32_32x32x16_bf16 v[40:55], v[208:211], v[60:63], v[40:55]
    ds_read_b128 v[56:59], v11 offset:32768
    ds_read_b128 v[60:63], v11 offset:34816
    s_waitcnt lgkmcnt(2)
    v_mfma_f32_32x32x16_bf16 v[24:39], v[212:215], v[64:67], v[24:39]
    v_mfma_f32_32x32x16_bf16 v[40:55], v[212:215], v[68:71], v[40:55]
    ds_read_b128 v[64:67], v12 offset:32768
    ds_read_b128 v[68:71], v12 offset:34816
    s_add_u32 m0, s7, 20480
    v_add_u32_dpp v7, v93, v2 quad_perm:[2,2,2,2] row_mask:0xf bank_mask:0xf
    buffer_load_dwordx4 v7, s[12:15], 0 offen lds
    s_waitcnt lgkmcnt(2)
    v_mfma_f32_32x32x16_bf16 v[24:39], v[216:219], v[56:59], v[24:39]
    v_mfma_f32_32x32x16_bf16 v[40:55], v[216:219], v[60:63], v[40:55]
    ds_read_b128 v[56:59], v11 offset:36864
    ds_read_b128 v[60:63], v11 offset:38912
    s_waitcnt lgkmcnt(2)
    v_mfma_f32_32x32x16_bf16 v[24:39], v[220:223], v[64:67], v[24:39]
    v_mfma_f32_32x32x16_bf16 v[40:55], v[220:223], v[68:71], v[40:55]
    ds_read_b128 v[64:67], v12 offset:36864
    ds_read_b128 v[68:71], v12 offset:38912
    s_add_u32 m0, s7, 24576
    v_add_u32_dpp v6, v94, v2 quad_perm:[2,2,2,2] row_mask:0xf bank_mask:0xf
    buffer_load_dwordx4 v6, s[12:15], 0 offen lds
    s_waitcnt lgkmcnt(2)
    v_mfma_f32_32x32x16_bf16 v[24:39], v[224:227], v[56:59], v[24:39]
    v_mfma_f32_32x32x16_bf16 v[40:55], v[224:227], v[60:63], v[40:55]
    s_waitcnt vmcnt(8)
    s_waitcnt vmcnt(6)
    s_barrier
    s_and_b32 s77, s92, 0xfc
    s_and_b32 s91, s92, 3
    s_lshl_b32 s91, s91, 3
    s_lshl_b32 s91, 1, s91
    v_mov_b32 v22, s77
    v_mov_b32 v23, s91
    s_and_b64 exec, s[100:101], 1
    buffer_atomic_add v23, v22, s[24:27], 0 offen sc1
    s_mov_b64 exec, -1
    ds_read_b128 v[56:59], v11 offset:40960
    ds_read_b128 v[60:63], v11 offset:43008
    s_waitcnt lgkmcnt(2)
    v_mfma_f32_32x32x16_bf16 v[24:39], v[228:231], v[64:67], v[24:39]
    v_mfma_f32_32x32x16_bf16 v[40:55], v[228:231], v[68:71], v[40:55]
    ds_read_b128 v[64:67], v12 offset:40960
    ds_read_b128 v[68:71], v12 offset:43008
    s_add_u32 m0, s7, 28672
    v_add_u32_dpp v7, v95, v2 quad_perm:[2,2,2,2] row_mask:0xf bank_mask:0xf
    buffer_load_dwordx4 v7, s[12:15], 0 offen lds
    s_waitcnt lgkmcnt(2)
    v_mfma_f32_32x32x16_bf16 v[24:39], v[232:235], v[56:59], v[24:39]
    v_mfma_f32_32x32x16_bf16 v[40:55], v[232:235], v[60:63], v[40:55]
    ds_read_b128 v[56:59], v11 offset:45056
    ds_read_b128 v[60:63], v11 offset:47104
    s_waitcnt lgkmcnt(2)
    v_mfma_f32_32x32x16_bf16 v[24:39], v[236:239], v[64:67], v[24:39]
    v_mfma_f32_32x32x16_bf16 v[40:55], v[236:239], v[68:71], v[40:55]
    ds_read_b128 v[64:67], v12 offset:45056
    ds_read_b128 v[68:71], v12 offset:47104
    s_add_u32 m0, s7, 32768
    v_add_u32_dpp v6, v92, v2 quad_perm:[3,3,3,3] row_mask:0xf bank_mask:0xf
    buffer_load_dwordx4 v6, s[12:15], 0 offen lds
    s_waitcnt lgkmcnt(2)
    v_mfma_f32_32x32x16_bf16 v[24:39], v[240:243], v[56:59], v[24:39]
    v_mfma_f32_32x32x16_bf16 v[40:55], v[240:243], v[60:63], v[40:55]
    ds_read_b128 v[56:59], v11 offset:49152
    ds_read_b128 v[60:63], v11 offset:51200
    s_waitcnt lgkmcnt(2)
    v_mfma_f32_32x32x16_bf16 v[24:39], v[244:247], v[64:67], v[24:39]
    v_mfma_f32_32x32x16_bf16 v[40:55], v[244:247], v[68:71], v[40:55]
    ds_read_b128 v[64:67], v12 offset:49152
    ds_read_b128 v[68:71], v12 offset:51200
    s_add_u32 m0, s7, 36864
    v_add_u32_dpp v7, v93, v2 quad_perm:[3,3,3,3] row_mask:0xf bank_mask:0xf
    buffer_load_dwordx4 v7, s[12:15], 0 offen lds
    s_waitcnt lgkmcnt(2)
    v_mfma_f32_32x32x16_bf16 v[24:39], v[248:251], v[56:59], v[24:39]
    v_mfma_f32_32x32x16_bf16 v[40:55], v[248:251], v[60:63], v[40:55]
    ds_read_b128 v[56:59], v11 offset:53248
    ds_read_b128 v[60:63], v11 offset:55296
    s_waitcnt lgkmcnt(2)
    v_mfma_f32_32x32x16_bf16 v[24:39], v[252:255], v[64:67], v[24:39]
    v_mfma_f32_32x32x16_bf16 v[40:55], v[252:255], v[68:71], v[40:55]
    ds_read_b128 v[64:67], v12 offset:53248
    ds_read_b128 v[68:71], v12 offset:55296
    s_add_u32 m0, s7, 122880
    v_add_u32_dpp v6, v94, v2 quad_perm:[3,3,3,3] row_mask:0xf bank_mask:0xf
    buffer_load_dwordx4 v6, s[12:15], 0 offen lds
    s_waitcnt lgkmcnt(2)
    v_mfma_f32_32x32x16_bf16 v[24:39], a[0:3], v[56:59], v[24:39]
    v_mfma_f32_32x32x16_bf16 v[40:55], a[0:3], v[60:63], v[40:55]
    ds_read_b128 v[56:59], v11 offset:57344
    ds_read_b128 v[60:63], v11 offset:59392
    s_waitcnt lgkmcnt(2)
    v_mfma_f32_32x32x16_bf16 v[24:39], a[4:7], v[64:67], v[24:39]
    v_mfma_f32_32x32x16_bf16 v[40:55], a[4:7], v[68:71], v[40:55]
    ds_read_b128 v[64:67], v12 offset:57344
    ds_read_b128 v[68:71], v12 offset:59392
    s_add_u32 m0, s7, 126976
    v_add_u32_dpp v7, v95, v2 quad_perm:[3,3,3,3] row_mask:0xf bank_mask:0xf
    buffer_load_dwordx4 v7, s[12:15], 0 offen lds
    s_waitcnt lgkmcnt(2)
    v_mfma_f32_32x32x16_bf16 v[24:39], a[8:11], v[56:59], v[24:39]
    v_mfma_f32_32x32x16_bf16 v[40:55], a[8:11], v[60:63], v[40:55]
    s_waitcnt vmcnt(8)
    s_barrier
    ds_read_b128 v[56:59], v9 offset:0
    ds_read_b128 v[60:63], v9 offset:2048
    s_waitcnt lgkmcnt(2)
    v_mfma_f32_32x32x16_bf16 v[24:39], a[12:15], v[64:67], v[24:39]
    v_mfma_f32_32x32x16_bf16 v[40:55], a[12:15], v[68:71], v[40:55]
    ds_read_b128 v[64:67], v10 offset:0
    ds_read_b128 v[68:71], v10 offset:2048
    s_lshl_b32 s77, s60, 16
    v_mov_b32 v160, s77
    s_and_b32 s77, s60, 0xffff0000
    v_mov_b32 v161, s77
    s_lshl_b32 s77, s61, 16
    v_mov_b32 v162, s77
    s_and_b32 s77, s61, 0xffff0000
    v_mov_b32 v163, s77
    s_lshl_b32 s77, s64, 16
    v_mov_b32 v164, s77
    s_and_b32 s77, s64, 0xffff0000
    v_mov_b32 v165, s77
    s_lshl_b32 s77, s65, 16
    v_mov_b32 v166, s77
    s_and_b32 s77, s65, 0xffff0000
    v_mov_b32 v167, s77
    s_lshl_b32 s77, s68, 16
    v_mov_b32 v168, s77
    s_and_b32 s77, s68, 0xffff0000
    v_mov_b32 v169, s77
    s_lshl_b32 s77, s69, 16
    v_mov_b32 v170, s77
    s_and_b32 s77, s69, 0xffff0000
    v_mov_b32 v171, s77
    s_lshl_b32 s77, s72, 16
    v_mov_b32 v172, s77
    s_and_b32 s77, s72, 0xffff0000
    v_mov_b32 v173, s77
    s_lshl_b32 s77, s73, 16
    v_mov_b32 v174, s77
    s_and_b32 s77, s73, 0xffff0000
    v_mov_b32 v175, s77
    s_mov_b32 exec_lo, 0
    s_lshl_b32 s77, s62, 16
    v_mov_b32 v160, s77
    s_and_b32 s77, s62, 0xffff0000
    v_mov_b32 v161, s77
    s_lshl_b32 s77, s63, 16
    v_mov_b32 v162, s77
    s_and_b32 s77, s63, 0xffff0000
    v_mov_b32 v163, s77
    s_lshl_b32 s77, s66, 16
    v_mov_b32 v164, s77
    s_and_b32 s77, s66, 0xffff0000
    v_mov_b32 v165, s77
    s_lshl_b32 s77, s67, 16
    v_mov_b32 v166, s77
    s_and_b32 s77, s67, 0xffff0000
    v_mov_b32 v167, s77
    s_lshl_b32 s77, s70, 16
    v_mov_b32 v168, s77
    s_and_b32 s77, s70, 0xffff0000
    v_mov_b32 v169, s77
    s_lshl_b32 s77, s71, 16
    v_mov_b32 v170, s77
    s_and_b32 s77, s71, 0xffff0000
    v_mov_b32 v171, s77
    s_lshl_b32 s77, s74, 16
    v_mov_b32 v172, s77
    s_and_b32 s77, s74, 0xffff0000
    v_mov_b32 v173, s77
    s_lshl_b32 s77, s75, 16
    v_mov_b32 v174, s77
    s_and_b32 s77, s75, 0xffff0000
    v_mov_b32 v175, s77
    s_mov_b32 exec_lo, -1
    s_add_u32 m0, s7, 131072
    v_add_u32_dpp v6, v96, v2 quad_perm:[0,0,0,0] row_mask:0xf bank_mask:0xf
    buffer_load_dwordx4 v6, s[12:15], 0 offen lds
    s_waitcnt lgkmcnt(2)
    v_mfma_f32_32x32x16_bf16 v[24:39], a[16:19], v[56:59], v[24:39]
    v_mfma_f32_32x32x16_bf16 v[40:55], a[16:19], v[60:63], v[40:55]
    ds_read_b128 v[56:59], v9 offset:4096
    ds_read_b128 v[60:63], v9 offset:6144
    s_waitcnt lgkmcnt(2)
    v_mfma_f32_32x32x16_bf16 v[24:39], a[20:23], v[64:67], v[24:39]
    v_mfma_f32_32x32x16_bf16 v[40:55], a[20:23], v[68:71], v[40:55]
    ds_read_b128 v[64:67], v10 offset:4096
    ds_read_b128 v[68:71], v10 offset:6144
    s_add_u32 m0, s7, 135168
    v_add_u32_dpp v7, v97, v2 quad_perm:[0,0,0,0] row_mask:0xf bank_mask:0xf
    buffer_load_dwordx4 v7, s[12:15], 0 offen lds
    s_waitcnt lgkmcnt(2)
    v_mfma_f32_32x32x16_bf16 v[24:39], a[24:27], v[56:59], v[24:39]
    v_mfma_f32_32x32x16_bf16 v[40:55], a[24:27], v[60:63], v[40:55]
    ds_read_b128 v[56:59], v9 offset:8192
    ds_read_b128 v[60:63], v9 offset:10240
    s_waitcnt lgkmcnt(2)
    v_mfma_f32_32x32x16_bf16 v[24:39], a[28:31], v[64:67], v[24:39]
    v_mfma_f32_32x32x16_bf16 v[40:55], a[28:31], v[68:71], v[40:55]
    ds_read_b128 v[64:67], v10 offset:8192
    ds_read_b128 v[68:71], v10 offset:10240
    s_add_u32 m0, s7, 139264
    v_add_u32_dpp v6, v98, v2 quad_perm:[0,0,0,0] row_mask:0xf bank_mask:0xf
    buffer_load_dwordx4 v6, s[12:15], 0 offen lds
    s_waitcnt lgkmcnt(2)
    v_mfma_f32_32x32x16_bf16 v[24:39], a[32:35], v[56:59], v[24:39]
    v_mfma_f32_32x32x16_bf16 v[40:55], a[32:35], v[60:63], v[40:55]
    ds_read_b128 v[56:59], v9 offset:12288
    ds_read_b128 v[60:63], v9 offset:14336
    s_waitcnt lgkmcnt(2)
    v_mfma_f32_32x32x16_bf16 v[24:39], a[36:39], v[64:67], v[24:39]
    v_mfma_f32_32x32x16_bf16 v[40:55], a[36:39], v[68:71], v[40:55]
    ds_read_b128 v[64:67], v10 offset:12288
    ds_read_b128 v[68:71], v10 offset:14336
    s_add_u32 m0, s7, 143360
    v_add_u32_dpp v7, v99, v2 quad_perm:[0,0,0,0] row_mask:0xf bank_mask:0xf
    buffer_load_dwordx4 v7, s[12:15], 0 offen lds
    s_waitcnt lgkmcnt(2)
    v_mfma_f32_32x32x16_bf16 v[24:39], a[40:43], v[56:59], v[24:39]
    v_mfma_f32_32x32x16_bf16 v[40:55], a[40:43], v[60:63], v[40:55]
    ds_read_b128 v[56:59], v9 offset:16384
    ds_read_b128 v[60:63], v9 offset:18432
    s_waitcnt lgkmcnt(2)
    v_mfma_f32_32x32x16_bf16 v[24:39], a[44:47], v[64:67], v[24:39]
    v_mfma_f32_32x32x16_bf16 v[40:55], a[44:47], v[68:71], v[40:55]
    ds_read_b128 v[64:67], v10 offset:16384
    ds_read_b128 v[68:71], v10 offset:18432
    s_add_u32 m0, s7, 147456
    v_add_u32_dpp v6, v96, v2 quad_perm:[1,1,1,1] row_mask:0xf bank_mask:0xf
    buffer_load_dwordx4 v6, s[12:15], 0 offen lds
    s_waitcnt lgkmcnt(2)
    v_mfma_f32_32x32x16_bf16 v[24:39], a[48:51], v[56:59], v[24:39]
    v_mfma_f32_32x32x16_bf16 v[40:55], a[48:51], v[60:63], v[40:55]
    s_waitcnt vmcnt(7)
    s_barrier
    ds_read_b128 v[56:59], v9 offset:20480
    ds_read_b128 v[60:63], v9 offset:22528
    s_waitcnt lgkmcnt(2)
    v_mfma_f32_32x32x16_bf16 v[24:39], a[52:55], v[64:67], v[24:39]
    v_mfma_f32_32x32x16_bf16 v[40:55], a[52:55], v[68:71], v[40:55]
    ds_read_b128 v[64:67], v10 offset:20480
    ds_read_b128 v[68:71], v10 offset:22528
    s_add_u32 m0, s7, 151552
    v_add_u32_dpp v7, v97, v2 quad_perm:[1,1,1,1] row_mask:0xf bank_mask:0xf
    buffer_load_dwordx4 v7, s[12:15], 0 offen lds
    s_waitcnt lgkmcnt(2)
    v_mfma_f32_32x32x16_bf16 v[24:39], a[56:59], v[56:59], v[24:39]
    v_mfma_f32_32x32x16_bf16 v[40:55], a[56:59], v[60:63], v[40:55]
    ds_read_b128 v[56:59], v9 offset:24576
    ds_read_b128 v[60:63], v9 offset:26624
    s_waitcnt lgkmcnt(2)
    v_mfma_f32_32x32x16_bf16 v[24:39], a[60:63], v[64:67], v[24:39]
    v_mfma_f32_32x32x16_bf16 v[40:55], a[60:63], v[68:71], v[40:55]
    ds_read_b128 v[64:67], v10 offset:24576
    ds_read_b128 v[68:71], v10 offset:26624
    s_add_u32 m0, s7, 155648
    v_add_u32_dpp v6, v98, v2 quad_perm:[1,1,1,1] row_mask:0xf bank_mask:0xf
    buffer_load_dwordx4 v6, s[12:15], 0 offen lds
    s_waitcnt lgkmcnt(2)
    v_mfma_f32_32x32x16_bf16 v[24:39], a[64:67], v[56:59], v[24:39]
    v_mfma_f32_32x32x16_bf16 v[40:55], a[64:67], v[60:63], v[40:55]
    ds_read_b128 v[56:59], v9 offset:28672
    ds_read_b128 v[60:63], v9 offset:30720
    s_waitcnt lgkmcnt(2)
    v_mfma_f32_32x32x16_bf16 v[24:39], a[68:71], v[64:67], v[24:39]
    v_mfma_f32_32x32x16_bf16 v[40:55], a[68:71], v[68:71], v[40:55]
    ds_read_b128 v[64:67], v10 offset:28672
    ds_read_b128 v[68:71], v10 offset:30720
    s_add_u32 m0, s7, 159744
    v_add_u32_dpp v7, v99, v2 quad_perm:[1,1,1,1] row_mask:0xf bank_mask:0xf
    buffer_load_dwordx4 v7, s[12:15], 0 offen lds
    s_waitcnt lgkmcnt(2)
    v_mfma_f32_32x32x16_bf16 v[24:39], a[72:75], v[56:59], v[24:39]
    v_mfma_f32_32x32x16_bf16 v[40:55], a[72:75], v[60:63], v[40:55]
    ds_read_b128 v[56:59], v9 offset:32768
    ds_read_b128 v[60:63], v9 offset:34816
    s_waitcnt lgkmcnt(2)
    v_mfma_f32_32x32x16_bf16 v[24:39], a[76:79], v[64:67], v[24:39]
    v_mfma_f32_32x32x16_bf16 v[40:55], a[76:79], v[68:71], v[40:55]
    ds_read_b128 v[64:67], v10 offset:32768
    ds_read_b128 v[68:71], v10 offset:34816
    s_add_u32 m0, s7, 40960
    v_add_u32_dpp v6, v96, v2 quad_perm:[2,2,2,2] row_mask:0xf bank_mask:0xf
    buffer_load_dwordx4 v6, s[12:15], 0 offen lds
    s_waitcnt lgkmcnt(2)
    v_mfma_f32_32x32x16_bf16 v[24:39], a[80:83], v[56:59], v[24:39]
    v_mfma_f32_32x32x16_bf16 v[40:55], a[80:83], v[60:63], v[40:55]
    ds_read_b128 v[56:59], v9 offset:36864
    ds_read_b128 v[60:63], v9 offset:38912
    s_waitcnt lgkmcnt(2)
    v_mfma_f32_32x32x16_bf16 v[24:39], a[84:87], v[64:67], v[24:39]
    v_mfma_f32_32x32x16_bf16 v[40:55], a[84:87], v[68:71], v[40:55]
    ds_read_b128 v[64:67], v10 offset:36864
    ds_read_b128 v[68:71], v10 offset:38912
    s_add_u32 m0, s7, 45056
    v_add_u32_dpp v7, v97, v2 quad_perm:[2,2,2,2] row_mask:0xf bank_mask:0xf
    buffer_load_dwordx4 v7, s[12:15], 0 offen lds
    s_waitcnt lgkmcnt(2)
    v_mfma_f32_32x32x16_bf16 v[24:39], a[88:91], v[56:59], v[24:39]
    v_mfma_f32_32x32x16_bf16 v[40:55], a[88:91], v[60:63], v[40:55]
    s_waitcnt vmcnt(7)
    s_barrier
    s_and_b32 s77, s92, 0xfc
    v_mov_b32 v22, s77
    s_and_b64 exec, s[100:101], 1
    buffer_load_dword v20, v22, s[24:27], 0 offen sc1
    s_mov_b64 exec, -1
    ds_read_b128 v[56:59], v13 offset:0
    ds_read_b128 v[60:63], v13 offset:2048
    s_waitcnt lgkmcnt(2)
    v_mfma_f32_32x32x16_bf16 v[24:39], a[92:95], v[64:67], v[24:39]
    v_mfma_f32_32x32x16_bf16 v[40:55], a[92:95], v[68:71], v[40:55]
    ds_read_b128 v[64:67], v14 offset:0
    ds_read_b128 v[68:71], v14 offset:2048
    s_add_u32 m0, s7, 49152
    v_add_u32_dpp v6, v98, v2 quad_perm:[2,2,2,2] row_mask:0xf bank_mask:0xf
    buffer_load_dwordx4 v6, s[12:15], 0 offen lds
    s_waitcnt lgkmcnt(2)
    v_mfma_f32_32x32x16_bf16 v[24:39], a[96:99], v[56:59], v[24:39]
    v_mfma_f32_32x32x16_bf16 v[40:55], a[96:99], v[60:63], v[40:55]
    ds_read_b128 v[56:59], v13 offset:4096
    ds_read_b128 v[60:63], v13 offset:6144
    s_waitcnt lgkmcnt(2)
    v_mfma_f32_32x32x16_bf16 v[24:39], a[100:103], v[64:67], v[24:39]
    v_mfma_f32_32x32x16_bf16 v[40:55], a[100:103], v[68:71], v[40:55]
    ds_read_b128 v[64:67], v14 offset:4096
    ds_read_b128 v[68:71], v14 offset:6144
    s_add_u32 m0, s7, 53248
    v_add_u32_dpp v7, v99, v2 quad_perm:[2,2,2,2] row_mask:0xf bank_mask:0xf
    buffer_load_dwordx4 v7, s[12:15], 0 offen lds
    s_waitcnt lgkmcnt(2)
    v_mfma_f32_32x32x16_bf16 v[24:39], a[104:107], v[56:59], v[24:39]
    v_mfma_f32_32x32x16_bf16 v[40:55], a[104:107], v[60:63], v[40:55]
    ds_read_b128 v[56:59], v13 offset:8192
    ds_read_b128 v[60:63], v13 offset:10240
    s_waitcnt lgkmcnt(2)
    v_mfma_f32_32x32x16_bf16 v[24:39], a[108:111], v[64:67], v[24:39]
    v_mfma_f32_32x32x16_bf16 v[40:55], a[108:111], v[68:71], v[40:55]
    ds_read_b128 v[64:67], v14 offset:8192
    ds_read_b128 v[68:71], v14 offset:10240
    s_add_u32 m0, s7, 57344
    v_add_u32_dpp v6, v96, v2 quad_perm:[3,3,3,3] row_mask:0xf bank_mask:0xf
    buffer_load_dwordx4 v6, s[12:15], 0 offen lds
    s_waitcnt lgkmcnt(2)
    v_mfma_f32_32x32x16_bf16 v[24:39], a[112:115], v[56:59], v[24:39]
    v_mfma_f32_32x32x16_bf16 v[40:55], a[112:115], v[60:63], v[40:55]
    ds_read_b128 v[56:59], v13 offset:12288
    ds_read_b128 v[60:63], v13 offset:14336
    s_waitcnt lgkmcnt(2)
    v_mfma_f32_32x32x16_bf16 v[24:39], a[116:119], v[64:67], v[24:39]
    v_mfma_f32_32x32x16_bf16 v[40:55], a[116:119], v[68:71], v[40:55]
    ds_read_b128 v[64:67], v14 offset:12288
    ds_read_b128 v[68:71], v14 offset:14336
    s_add_u32 m0, s7, 61440
    v_add_u32_dpp v7, v97, v2 quad_perm:[3,3,3,3] row_mask:0xf bank_mask:0xf
    buffer_load_dwordx4 v7, s[12:15], 0 offen lds
    s_waitcnt lgkmcnt(2)
    v_mfma_f32_32x32x16_bf16 v[24:39], a[120:123], v[56:59], v[24:39]
    v_mfma_f32_32x32x16_bf16 v[40:55], a[120:123], v[60:63], v[40:55]
    ds_read_b128 v[56:59], v13 offset:16384
    ds_read_b128 v[60:63], v13 offset:18432
    s_waitcnt lgkmcnt(2)
    v_mfma_f32_32x32x16_bf16 v[24:39], a[124:127], v[64:67], v[24:39]
    v_mfma_f32_32x32x16_bf16 v[40:55], a[124:127], v[68:71], v[40:55]
    ds_read_b128 v[64:67], v14 offset:16384
    ds_read_b128 v[68:71], v14 offset:18432
    s_add_u32 m0, s7, 65536
    v_add_u32_dpp v6, v98, v2 quad_perm:[3,3,3,3] row_mask:0xf bank_mask:0xf
    buffer_load_dwordx4 v6, s[12:15], 0 offen lds
    s_waitcnt lgkmcnt(2)
    v_mfma_f32_32x32x16_bf16 v[24:39], a[128:131], v[56:59], v[24:39]
    v_mfma_f32_32x32x16_bf16 v[40:55], a[128:131], v[60:63], v[40:55]
    s_waitcnt vmcnt(8)
    s_barrier
    ds_read_b128 v[56:59], v13 offset:20480
    ds_read_b128 v[60:63], v13 offset:22528
    s_waitcnt lgkmcnt(2)
    v_mfma_f32_32x32x16_bf16 v[24:39], a[132:135], v[64:67], v[24:39]
    v_mfma_f32_32x32x16_bf16 v[40:55], a[132:135], v[68:71], v[40:55]
    ds_read_b128 v[64:67], v14 offset:20480
    ds_read_b128 v[68:71], v14 offset:22528
    s_add_u32 m0, s7, 69632
    v_add_u32_dpp v7, v99, v2 quad_perm:[3,3,3,3] row_mask:0xf bank_mask:0xf
    buffer_load_dwordx4 v7, s[12:15], 0 offen lds
    s_waitcnt lgkmcnt(2)
    v_mfma_f32_32x32x16_bf16 v[24:39], a[136:139], v[56:59], v[24:39]
    v_mfma_f32_32x32x16_bf16 v[40:55], a[136:139], v[60:63], v[40:55]
    ds_read_b128 v[56:59], v13 offset:24576
    ds_read_b128 v[60:63], v13 offset:26624
    s_waitcnt lgkmcnt(2)
    v_mfma_f32_32x32x16_bf16 v[24:39], a[140:143], v[64:67], v[24:39]
    v_mfma_f32_32x32x16_bf16 v[40:55], a[140:143], v[68:71], v[40:55]
    ds_read_b128 v[64:67], v14 offset:24576
    ds_read_b128 v[68:71], v14 offset:26624
    s_add_u32 m0, s7, 73728
    v_add_u32_dpp v6, v100, v2 quad_perm:[0,0,0,0] row_mask:0xf bank_mask:0xf
    buffer_load_dwordx4 v6, s[12:15], 0 offen lds
    s_waitcnt lgkmcnt(2)
    v_mfma_f32_32x32x16_bf16 v[24:39], a[144:147], v[56:59], v[24:39]
    v_mfma_f32_32x32x16_bf16 v[40:55], a[144:147], v[60:63], v[40:55]
    ds_read_b128 v[56:59], v13 offset:28672
    ds_read_b128 v[60:63], v13 offset:30720
    s_waitcnt lgkmcnt(2)
    v_mfma_f32_32x32x16_bf16 v[24:39], a[148:151], v[64:67], v[24:39]
    v_mfma_f32_32x32x16_bf16 v[40:55], a[148:151], v[68:71], v[40:55]
    ds_read_b128 v[64:67], v14 offset:28672
    ds_read_b128 v[68:71], v14 offset:30720
    s_add_u32 m0, s7, 77824
    v_add_u32_dpp v7, v101, v2 quad_perm:[0,0,0,0] row_mask:0xf bank_mask:0xf
    buffer_load_dwordx4 v7, s[12:15], 0 offen lds
    s_waitcnt lgkmcnt(2)
    v_mfma_f32_32x32x16_bf16 v[24:39], a[152:155], v[56:59], v[24:39]
    v_mfma_f32_32x32x16_bf16 v[40:55], a[152:155], v[60:63], v[40:55]
    ds_read_b128 v[56:59], v13 offset:32768
    ds_read_b128 v[60:63], v13 offset:34816
    s_waitcnt lgkmcnt(2)
    v_mfma_f32_32x32x16_bf16 v[24:39], a[156:159], v[64:67], v[24:39]
    v_mfma_f32_32x32x16_bf16 v[40:55], a[156:159], v[68:71], v[40:55]
    ds_read_b128 v[64:67], v14 offset:32768
    ds_read_b128 v[68:71], v14 offset:34816
    s_waitcnt lgkmcnt(2)
    v_mfma_f32_32x32x16_bf16 v[24:39], a[160:163], v[56:59], v[24:39]
    v_mfma_f32_32x32x16_bf16 v[40:55], a[160:163], v[60:63], v[40:55]
    ds_read_b128 v[56:59], v13 offset:36864
    ds_read_b128 v[60:63], v13 offset:38912
    s_waitcnt lgkmcnt(2)
    v_mfma_f32_32x32x16_bf16 v[24:39], a[164:167], v[64:67], v[24:39]
    v_mfma_f32_32x32x16_bf16 v[40:55], a[164:167], v[68:71], v[40:55]
    ds_read_b128 v[64:67], v14 offset:36864
    ds_read_b128 v[68:71], v14 offset:38912
    s_waitcnt lgkmcnt(2)
    v_mfma_f32_32x32x16_bf16 v[24:39], a[168:171], v[56:59], v[24:39]
    v_mfma_f32_32x32x16_bf16 v[40:55], a[168:171], v[60:63], v[40:55]
    s_waitcnt vmcnt(5)
    s_cmp_lg_u32 s3, 0
    s_cbranch_scc1 L_ready
    s_xor_b32 s77, s92, 1
    s_and_b32 s77, s77, 3
    s_lshl_b32 s77, s77, 3
    s_mov_b32 s94, 262144
L_poll:
    v_readfirstlane_b32 s91, v20
    s_nop 3
    s_lshr_b32 s91, s91, s77
    s_and_b32 s91, s91, 255
    s_cmp_ge_u32 s91, 1
    s_cbranch_scc1 L_ready
    s_sub_u32 s94, s94, 1
    s_cbranch_scc1 L_ready
    s_sleep 4
    buffer_load_dword v20, v22, s[24:27], 0 offen sc1
    s_waitcnt vmcnt(0)
    s_branch L_poll
L_ready:
    s_barrier
    buffer_load_dwordx4 v[112:115], v5, s[20:23], s95 offen offset:0 sc1
    buffer_load_dwordx4 v[116:119], v5, s[20:23], s95 offen offset:1024 sc1
    buffer_load_dwordx4 v[120:123], v5, s[20:23], s95 offen offset:2048 sc1
    buffer_load_dwordx4 v[124:127], v5, s[20:23], s95 offen offset:3072 sc1
    ds_read_b128 v[56:59], v9 offset:40960
    ds_read_b128 v[60:63], v9 offset:43008
    s_waitcnt lgkmcnt(2)
    v_mfma_f32_32x32x16_bf16 v[24:39], a[172:175], v[64:67], v[24:39]
    v_mfma_f32_32x32x16_bf16 v[40:55], a[172:175], v[68:71], v[40:55]
    ds_read_b128 v[64:67], v10 offset:40960
    ds_read_b128 v[68:71], v10 offset:43008
    s_waitcnt lgkmcnt(2)
    v_mfma_f32_32x32x16_bf16 v[24:39], a[176:179], v[56:59], v[24:39]
    v_mfma_f32_32x32x16_bf16 v[40:55], a[176:179], v[60:63], v[40:55]
    ds_read_b128 v[56:59], v9 offset:45056
    ds_read_b128 v[60:63], v9 offset:47104
    s_waitcnt lgkmcnt(2)
    v_mfma_f32_32x32x16_bf16 v[24:39], a[180:183], v[64:67], v[24:39]
    v_mfma_f32_32x32x16_bf16 v[40:55], a[180:183], v[68:71], v[40:55]
    ds_read_b128 v[64:67], v10 offset:45056
    ds_read_b128 v[68:71], v10 offset:47104
    s_waitcnt lgkmcnt(2)
    v_mfma_f32_32x32x16_bf16 v[24:39], a[184:187], v[56:59], v[24:39]
    v_mfma_f32_32x32x16_bf16 v[40:55], a[184:187], v[60:63], v[40:55]
    ds_read_b128 v[56:59], v9 offset:49152
    ds_read_b128 v[60:63], v9 offset:51200
    s_waitcnt lgkmcnt(2)
    v_mfma_f32_32x32x16_bf16 v[24:39], a[188:191], v[64:67], v[24:39]
    v_mfma_f32_32x32x16_bf16 v[40:55], a[188:191], v[68:71], v[40:55]
    ds_read_b128 v[64:67], v10 offset:49152
    ds_read_b128 v[68:71], v10 offset:51200
    s_waitcnt lgkmcnt(2)
    v_mfma_f32_32x32x16_bf16 v[24:39], a[192:195], v[56:59], v[24:39]
    v_mfma_f32_32x32x16_bf16 v[40:55], a[192:195], v[60:63], v[40:55]
    ds_read_b128 v[56:59], v9 offset:53248
    ds_read_b128 v[60:63], v9 offset:55296
    s_waitcnt lgkmcnt(2)
    v_mfma_f32_32x32x16_bf16 v[24:39], a[196:199], v[64:67], v[24:39]
    v_mfma_f32_32x32x16_bf16 v[40:55], a[196:199], v[68:71], v[40:55]
    ds_read_b128 v[64:67], v10 offset:53248
    ds_read_b128 v[68:71], v10 offset:55296
    s_waitcnt lgkmcnt(2)
    v_mfma_f32_32x32x16_bf16 v[24:39], a[200:203], v[56:59], v[24:39]
    v_mfma_f32_32x32x16_bf16 v[40:55], a[200:203], v[60:63], v[40:55]
    ds_read_b128 v[56:59], v9 offset:57344
    ds_read_b128 v[60:63], v9 offset:59392
    s_waitcnt lgkmcnt(2)
    v_mfma_f32_32x32x16_bf16 v[24:39], a[204:207], v[64:67], v[24:39]
    v_mfma_f32_32x32x16_bf16 v[40:55], a[204:207], v[68:71], v[40:55]
    ds_read_b128 v[64:67], v10 offset:57344
    ds_read_b128 v[68:71], v10 offset:59392
    s_waitcnt lgkmcnt(2)
    v_mfma_f32_32x32x16_bf16 v[24:39], a[208:211], v[56:59], v[24:39]
    v_mfma_f32_32x32x16_bf16 v[40:55], a[208:211], v[60:63], v[40:55]
    s_waitcnt vmcnt(4)
    s_barrier
    ds_read_b128 v[56:59], v11 offset:0
    ds_read_b128 v[60:63], v11 offset:2048
    s_waitcnt lgkmcnt(2)
    v_mfma_f32_32x32x16_bf16 v[24:39], a[212:215], v[64:67], v[24:39]
    v_mfma_f32_32x32x16_bf16 v[40:55], a[212:215], v[68:71], v[40:55]
    ds_read_b128 v[64:67], v12 offset:0
    ds_read_b128 v[68:71], v12 offset:2048
    s_waitcnt lgkmcnt(2)
    v_mfma_f32_32x32x16_bf16 v[24:39], a[216:219], v[56:59], v[24:39]
    v_mfma_f32_32x32x16_bf16 v[40:55], a[216:219], v[60:63], v[40:55]
    ds_read_b128 v[56:59], v11 offset:4096
    ds_read_b128 v[60:63], v11 offset:6144
    s_waitcnt lgkmcnt(2)
    v_mfma_f32_32x32x16_bf16 v[24:39], a[220:223], v[64:67], v[24:39]
    v_mfma_f32_32x32x16_bf16 v[40:55], a[220:223], v[68:71], v[40:55]
    ds_read_b128 v[64:67], v12 offset:4096
    ds_read_b128 v[68:71], v12 offset:6144
    s_waitcnt lgkmcnt(2)
    v_mfma_f32_32x32x16_bf16 v[24:39], a[224:227], v[56:59], v[24:39]
    v_mfma_f32_32x32x16_bf16 v[40:55], a[224:227], v[60:63], v[40:55]
    ds_read_b128 v[56:59], v11 offset:8192
    ds_read_b128 v[60:63], v11 offset:10240
    s_waitcnt lgkmcnt(2)
    v_mfma_f32_32x32x16_bf16 v[24:39], a[228:231], v[64:67], v[24:39]
    v_mfma_f32_32x32x16_bf16 v[40:55], a[228:231], v[68:71], v[40:55]
    ds_read_b128 v[64:67], v12 offset:8192
    ds_read_b128 v[68:71], v12 offset:10240
    s_waitcnt lgkmcnt(2)
    v_mfma_f32_32x32x16_bf16 v[24:39], a[232:235], v[56:59], v[24:39]
    v_mfma_f32_32x32x16_bf16 v[40:55], a[232:235], v[60:63], v[40:55]
    ds_read_b128 v[56:59], v11 offset:12288
    ds_read_b128 v[60:63], v11 offset:14336
    s_waitcnt lgkmcnt(2)
    v_mfma_f32_32x32x16_bf16 v[24:39], a[236:239], v[64:67], v[24:39]
    v_mfma_f32_32x32x16_bf16 v[40:55], a[236:239], v[68:71], v[40:55]
    ds_read_b128 v[64:67], v12 offset:12288
    ds_read_b128 v[68:71], v12 offset:14336
    s_waitcnt lgkmcnt(2)
    v_mfma_f32_32x32x16_bf16 v[24:39], a[240:243], v[56:59], v[24:39]
    v_mfma_f32_32x32x16_bf16 v[40:55], a[240:243], v[60:63], v[40:55]
    ds_read_b128 v[56:59], v11 offset:16384
    ds_read_b128 v[60:63], v11 offset:18432
    s_waitcnt lgkmcnt(2)
    v_mfma_f32_32x32x16_bf16 v[24:39], a[244:247], v[64:67], v[24:39]
    v_mfma_f32_32x32x16_bf16 v[40:55], a[244:247], v[68:71], v[40:55]
    ds_read_b128 v[64:67], v12 offset:16384
    ds_read_b128 v[68:71], v12 offset:18432
    s_waitcnt lgkmcnt(2)
    v_mfma_f32_32x32x16_bf16 v[24:39], a[248:251], v[56:59], v[24:39]
    v_mfma_f32_32x32x16_bf16 v[40:55], a[248:251], v[60:63], v[40:55]
    s_waitcnt lgkmcnt(0)
    v_mfma_f32_32x32x16_bf16 v[24:39], a[252:255], v[64:67], v[24:39]
    v_mfma_f32_32x32x16_bf16 v[40:55], a[252:255], v[68:71], v[40:55]
    s_waitcnt vmcnt(0)
    v_lshlrev_b32 v128, 16, v112
    v_and_b32 v129, 0xffff0000, v112
    v_lshlrev_b32 v130, 16, v113
    v_and_b32 v131, 0xffff0000, v113
    v_lshlrev_b32 v132, 16, v114
    v_and_b32 v133, 0xffff0000, v114
    v_lshlrev_b32 v134, 16, v115
    v_and_b32 v135, 0xffff0000, v115
    v_lshlrev_b32 v136, 16, v116
    v_and_b32 v137, 0xffff0000, v116
    v_lshlrev_b32 v138, 16, v117
    v_and_b32 v139, 0xffff0000, v117
    v_lshlrev_b32 v140, 16, v118
    v_and_b32 v141, 0xffff0000, v118
    v_lshlrev_b32 v142, 16, v119
    v_and_b32 v143, 0xffff0000, v119
    v_lshlrev_b32 v144, 16, v120
    v_and_b32 v145, 0xffff0000, v120
    v_lshlrev_b32 v146, 16, v121
    v_and_b32 v147, 0xffff0000, v121
    v_lshlrev_b32 v148, 16, v122
    v_and_b32 v149, 0xffff0000, v122
    v_lshlrev_b32 v150, 16, v123
    v_and_b32 v151, 0xffff0000, v123
    v_lshlrev_b32 v152, 16, v124
    v_and_b32 v153, 0xffff0000, v124
    v_lshlrev_b32 v154, 16, v125
    v_and_b32 v155, 0xffff0000, v125
    v_lshlrev_b32 v156, 16, v126
    v_and_b32 v157, 0xffff0000, v126
    v_lshlrev_b32 v158, 16, v127
    v_and_b32 v159, 0xffff0000, v127
    v_pk_add_f32 v[24:25], v[24:25], v[128:129]
    v_pk_add_f32 v[26:27], v[26:27], v[130:131]
    v_pk_add_f32 v[28:29], v[28:29], v[132:133]
    v_pk_add_f32 v[30:31], v[30:31], v[134:135]
    v_pk_add_f32 v[32:33], v[32:33], v[136:137]
    v_pk_add_f32 v[34:35], v[34:35], v[138:139]
    v_pk_add_f32 v[36:37], v[36:37], v[140:141]
    v_pk_add_f32 v[38:39], v[38:39], v[142:143]
    v_max_f32 v24, 0, v24
    v_max_f32 v25, 0, v25
    v_max_f32 v26, 0, v26
    v_max_f32 v27, 0, v27
    v_max_f32 v28, 0, v28
    v_max_f32 v29, 0, v29
    v_max_f32 v30, 0, v30
    v_max_f32 v31, 0, v31
    v_max_f32 v32, 0, v32
    v_max_f32 v33, 0, v33
    v_max_f32 v34, 0, v34
    v_max_f32 v35, 0, v35
    v_max_f32 v36, 0, v36
    v_max_f32 v37, 0, v37
    v_max_f32 v38, 0, v38
    v_max_f32 v39, 0, v39
    v_pk_mul_f32 v[56:57], v[24:25], v[160:161]
    v_pk_fma_f32 v[56:57], v[26:27], v[162:163], v[56:57]
    v_pk_fma_f32 v[56:57], v[28:29], v[164:165], v[56:57]
    v_pk_fma_f32 v[56:57], v[30:31], v[166:167], v[56:57]
    v_pk_fma_f32 v[56:57], v[32:33], v[168:169], v[56:57]
    v_pk_fma_f32 v[56:57], v[34:35], v[170:171], v[56:57]
    v_pk_fma_f32 v[56:57], v[36:37], v[172:173], v[56:57]
    v_pk_fma_f32 v[56:57], v[38:39], v[174:175], v[56:57]
    v_add_f32 v22, v56, v57
    v_pk_add_f32 v[40:41], v[40:41], v[144:145]
    v_pk_add_f32 v[42:43], v[42:43], v[146:147]
    v_pk_add_f32 v[44:45], v[44:45], v[148:149]
    v_pk_add_f32 v[46:47], v[46:47], v[150:151]
    v_pk_add_f32 v[48:49], v[48:49], v[152:153]
    v_pk_add_f32 v[50:51], v[50:51], v[154:155]
    v_pk_add_f32 v[52:53], v[52:53], v[156:157]
    v_pk_add_f32 v[54:55], v[54:55], v[158:159]
    v_max_f32 v40, 0, v40
    v_max_f32 v41, 0, v41
    v_max_f32 v42, 0, v42
    v_max_f32 v43, 0, v43
    v_max_f32 v44, 0, v44
    v_max_f32 v45, 0, v45
    v_max_f32 v46, 0, v46
    v_max_f32 v47, 0, v47
    v_max_f32 v48, 0, v48
    v_max_f32 v49, 0, v49
    v_max_f32 v50, 0, v50
    v_max_f32 v51, 0, v51
    v_max_f32 v52, 0, v52
    v_max_f32 v53, 0, v53
    v_max_f32 v54, 0, v54
    v_max_f32 v55, 0, v55
    v_pk_mul_f32 v[64:65], v[40:41], v[160:161]
    v_pk_fma_f32 v[64:65], v[42:43], v[162:163], v[64:65]
    v_pk_fma_f32 v[64:65], v[44:45], v[164:165], v[64:65]
    v_pk_fma_f32 v[64:65], v[46:47], v[166:167], v[64:65]
    v_pk_fma_f32 v[64:65], v[48:49], v[168:169], v[64:65]
    v_pk_fma_f32 v[64:65], v[50:51], v[170:171], v[64:65]
    v_pk_fma_f32 v[64:65], v[52:53], v[172:173], v[64:65]
    v_pk_fma_f32 v[64:65], v[54:55], v[174:175], v[64:65]
    v_add_f32 v23, v64, v65
    s_nop 1
    v_permlane32_swap_b32 v22, v23
    s_nop 1
    v_add_f32 v22, v22, v23
    s_lshl_b32 s77, s3, 8
    s_add_u32 s77, s77, 143360
    v_lshl_add_u32 v6, v1, 2, s77
    ds_write_b32 v6, v22
    s_waitcnt lgkmcnt(0)
    s_barrier
    s_cmp_lg_u32 s3, 0
    s_cbranch_scc1 L_done
    v_lshlrev_b32 v6, 2, v1
    v_add_u32 v6, 143360, v6
    ds_read2st64_b32 v[56:57], v6 offset0:0 offset1:1
    ds_read2st64_b32 v[58:59], v6 offset0:2 offset1:3
    s_lshr_b32 s77, s2, 1
    s_lshl_b32 s77, s77, 7
    s_and_b32 s91, s2, 1
    s_lshl_b32 s91, s91, 6
    s_add_u32 s77, s77, s91
    s_lshl_b32 s77, s77, 1
    v_lshlrev_b32 v7, 1, v1
    s_waitcnt lgkmcnt(0)
    v_add_f32 v56, v56, v57
    v_add_f32 v58, v58, v59
    v_add_f32 v21, v21, v56
    v_add_f32 v21, v21, v58
    v_mul_f32 v21, 0xbfb8aa3b, v21
    v_exp_f32 v21, v21
    s_nop 0
    v_add_f32 v21, 1.0, v21
    v_rcp_f32 v21, v21
    s_nop 0
    v_cvt_pk_bf16_f32 v21, v21, v21
    buffer_store_short v21, v7, s[28:31], s77 offen
L_done:
    s_endpgm
.section .rodata,"a"
.p2align 6
.amdhsa_kernel standalone__deep_cross_wide_deep__recsys_kernel
  .amdhsa_next_free_vgpr 512
  .amdhsa_next_free_sgpr 102
  .amdhsa_accum_offset 256
  .amdhsa_group_segment_fixed_size 0
  .amdhsa_kernarg_size 96
  .amdhsa_user_sgpr_count 2
  .amdhsa_user_sgpr_kernarg_segment_ptr 1
  .amdhsa_system_sgpr_workgroup_id_x 1
.end_amdhsa_kernel
```
